```python
import torch

def _softmax(x, axis=-1):
    return torch.softmax(x, dim=axis)
def _gelu(x):
    return torch.nn.functional.gelu(x, approximate="tanh")
def _silu(x):
    return torch.nn.functional.silu(x)
def _sigmoid(x):
    return torch.sigmoid(x)
def _layernorm(x, axis=-1, eps=1e-5):
    m = x.mean(dim=axis, keepdim=True)
    v = x.var(dim=axis, keepdim=True, unbiased=False)
    return (x - m) / torch.sqrt(v + eps)
def _scatter_add(tgt, idx, src, axis=0):
    return tgt.clone().index_add_(axis, idx, src)
def _segment_sum(src, seg, n):
    out = torch.zeros((n,) + src.shape[1:], dtype=src.dtype)
    return out.index_add_(0, seg, src)
def _pad(x, pw):
    flat = tuple(v for pair in reversed(pw) for v in pair)
    return torch.nn.functional.pad(x, flat)

kernel_name = 'gated_mix__grouped_kv_mqa__dense_activation_squared_relu__prompt'

def setup_inputs():

    _w = (lambda a: (lambda t: t.to(torch.bfloat16) if t.is_floating_point() else t)(torch.as_tensor(a)))
    def _A_setup():
        B, S, D, H = 1, 2048, 512, 32
        Dh = D // H
        return {
            "x": _w((lambda *s: torch.randn(*s, dtype=torch.bfloat16) * 0.05)(B, S, D)),
            "wq": _w((lambda *s: torch.randn(*s, dtype=torch.bfloat16) * 0.8)(D, H * Dh)),
            "wk": _w((lambda *s: torch.randn(*s, dtype=torch.bfloat16) * 0.8)(D, Dh)),
            "wv": _w((lambda *s: torch.randn(*s, dtype=torch.bfloat16) * 0.2)(D, Dh)),
            "wo": _w((lambda *s: torch.randn(*s, dtype=torch.bfloat16) * 0.2)(H * Dh, D)),
        }
    _A_in = _A_setup()

    def _B_setup():
        B, S, D, F = 1, 2048, 512, 1792
        return {
            "x": _w((lambda *s: torch.randn(*s, dtype=torch.bfloat16) * 0.05)(B, S, D)),
            "w1": _w((lambda *s: torch.randn(*s, dtype=torch.bfloat16) * 0.05)(D, F)),
            "b1": _w((lambda *s: torch.randn(*s, dtype=torch.bfloat16) * 0.05)(F)),
            "w2": _w((lambda *s: torch.randn(*s, dtype=torch.bfloat16) * 0.05)(F, D)),
            "b2": _w((lambda *s: torch.randn(*s, dtype=torch.bfloat16) * 0.05)(D)),
        }
    _B_in = _B_setup()

    return {
        "A_x": _A_in["x"],
        "A_wq": _A_in["wq"],
        "A_wk": _A_in["wk"],
        "A_wv": _A_in["wv"],
        "A_wo": _A_in["wo"],
        "B_x": _B_in["x"],
        "B_w1": _B_in["w1"],
        "B_b1": _B_in["b1"],
        "B_w2": _B_in["w2"],
        "B_b2": _B_in["b2"],
        "gate_w": _w((lambda *s: torch.randn(*s, dtype=torch.bfloat16) * 0.05)(512) * 16.0),
    }

def reference(A_x, A_wq, A_wk, A_wv, A_wo, B_x, B_w1, B_b1, B_w2, B_b2, gate_w):
    def _A_ref(x, wq, wk, wv, wo):
        B, S, D = x.shape
        H = 32
        Dh = D // H
        q = (lambda x, *d: x.permute(*d))((x @ wq).reshape(B, S, H, Dh), 0, 2, 1, 3)
        k = x @ wk
        v = x @ wv
        scores = torch.einsum("bhqd,bkd->bhqk", q, k) * (Dh ** -0.5)
        p = _softmax(scores, axis=-1)
        o = torch.einsum("bhqk,bkd->bhqd", p, v)
        return (lambda x, *d: x.permute(*d))(o, 0, 2, 1, 3).reshape(B, S, H * Dh) @ wo

    def _B_ref(x, w1, b1, w2, b2):
        h = torch.einsum("bsd,df->bsf", x, w1) + b1
        zero = torch.zeros_like(h)
        r = torch.where(h > zero, h, zero)
        h = r * r
        out = torch.einsum("bsf,fd->bsd", h, w2) + b2
        return out

    x = A_x
    g = _sigmoid((x * gate_w).sum(-1, keepdims=True))
    a = _A_ref(x, A_wq, A_wk, A_wv, A_wo)
    b = _B_ref(x, B_w1, B_b1, B_w2, B_b2)
    return g * a + (1 - g) * b
```

```asm
; @launch grid=(256,1,1) block=(512,1,1) lds=163840
.amdgcn_target "amdgcn-amd-amdhsa--gfx950"
.text
.globl gated_mix__grouped_kv_mqa__dense_activation_squared_relu__prompt_kernel
.p2align 8
.type gated_mix__grouped_kv_mqa__dense_activation_squared_relu__prompt_kernel,@function
gated_mix__grouped_kv_mqa__dense_activation_squared_relu__prompt_kernel:
    s_cmp_ge_u32 s2, 256
    s_cbranch_scc1 L_end
    s_load_dwordx4 s[12:15], s[0:1], 16
    s_load_dwordx2 s[4:5], s[0:1], 0
    s_load_dwordx2 s[8:9], s[0:1], 8
    s_load_dwordx2 s[44:45], s[0:1], 104
    s_getpc_b64 s[60:61]
    s_movk_i32 s62, 6144
    s_mov_b32 s63, 0x00020000
    v_lshlrev_b32 v2, 7, v0
    v_lshrrev_b32 v1, 6, v0
    buffer_load_dword v197, v2, s[60:63], 0 offen
    v_and_b32 v255, 63, v0
    v_readfirstlane_b32 s50, v1
    s_and_b32 s54, s2, 7
    s_bfe_u32 s52, s2, 0x30003
    s_lshr_b32 s55, s2, 6
    s_lshl2_add_u32 s51, s54, s55
    s_mov_b32 s6, 2097152
    s_mov_b32 s7, s63
    s_add_u32 s3, s54, s52
    s_and_b32 s3, s3, 3
    s_and_b32 s60, s52, 3
    v_lshrrev_b32 v3, 4, v255
    v_and_b32 v2, 15, v255
    v_xor_b32 v12, v3, v2
    v_lshlrev_b32 v12, 4, v12
    v_lshl_or_b32 v4, v3, 10, v12
    v_xor_b32 v5, 64, v4
    v_add_u32 v5, 3072, v5
    v_xor_b32 v6, 0x80, v4
    v_add_u32 v6, 6144, v6
    v_xor_b32 v7, 0xc0, v4
    v_add_u32 v7, 9216, v7
    v_lshlrev_b32 v1, 4, v255
    s_cmp_eq_u32 s50, 7
    s_cbranch_scc0 L_nKV
    s_setprio 3
    s_lshl2_add_u32 s64, s51, s60
    s_lshl_b32 s62, s64, 14
    s_lshl_b32 s65, s60, 12
    s_mov_b32 s61, s3
    v_and_b32 v8, 1, v3
    v_lshlrev_b32 v8, 9, v8
    v_lshl_or_b32 v8, v2, 4, v8
    v_lshrrev_b32 v9, 1, v3
    v_lshl_or_b32 v8, v9, 3, v8
    v_mov_b64 v[10:11], -1
    s_lshr_b32 s54, s64, 1
    s_lshl_b32 s54, s54, 10
    s_and_b32 s55, s64, 1
    s_lshl_b32 s55, s55, 8
    s_add_u32 s54, s54, s55
    s_add_u32 s54, s54, 524288
    s_add_u32 s55, s54, 65536
    s_mov_b32 s46, 16777216
    s_mov_b32 s47, s63
    s_lshl3_add_u32 s57, s51, s52
    s_lshl_b32 s57, s57, 5
    s_add_u32 s58, s57, 16384
    s_add_u32 s57, s57, 4096
    s_cmp_lt_u32 s52, 4
    s_cselect_b32 s54, s54, s55
    s_waitcnt lgkmcnt(0)
    buffer_store_dwordx2 v[10:11], v8, s[44:47], s54 offen sc1
    s_load_dword s53, s[44:45], 0
    s_load_dword s56, s[44:45], s57
    s_load_dword s56, s[44:45], s58
    s_cselect_b32 s12, s12, s14
    s_cselect_b32 s13, s13, s15
    s_movk_i32 s14, 16384
    s_mov_b32 s15, 0x00020000
    s_mov_b32 m0, 131072
    s_lshl_b32 s55, s61, 12
    buffer_load_dwordx4 v1, s[12:15], s55 offen offset:0 lds
    buffer_load_dwordx4 v1, s[12:15], s55 offen offset:1024 lds
    buffer_load_dwordx4 v1, s[12:15], s55 offen offset:2048 lds
    buffer_load_dwordx4 v1, s[12:15], s55 offen offset:3072 lds
    s_lshl_b32 s55, s61, 8
    s_add_u32 m0, s65, 0
    s_add_u32 s55, s55, s62
    buffer_load_dwordx4 v4, s[4:7], s55 offen offset:0 lds
    buffer_load_dwordx4 v5, s[4:7], s55 offen offset:1024 lds
    buffer_load_dwordx4 v6, s[4:7], s55 offen offset:2048 lds
    buffer_load_dwordx4 v7, s[4:7], s55 offen offset:3072 lds
    s_add_u32 s61, s61, 1
    s_and_b32 s61, s61, 3
    s_mov_b32 m0, 135168
    s_lshl_b32 s55, s61, 12
    buffer_load_dwordx4 v1, s[12:15], s55 offen offset:0 lds
    buffer_load_dwordx4 v1, s[12:15], s55 offen offset:1024 lds
    buffer_load_dwordx4 v1, s[12:15], s55 offen offset:2048 lds
    buffer_load_dwordx4 v1, s[12:15], s55 offen offset:3072 lds
    s_lshl_b32 s55, s61, 8
    s_add_u32 m0, s65, 16384
    s_add_u32 s55, s55, s62
    buffer_load_dwordx4 v4, s[4:7], s55 offen offset:0 lds
    buffer_load_dwordx4 v5, s[4:7], s55 offen offset:1024 lds
    buffer_load_dwordx4 v6, s[4:7], s55 offen offset:2048 lds
    buffer_load_dwordx4 v7, s[4:7], s55 offen offset:3072 lds
    s_add_u32 s61, s61, 1
    s_and_b32 s61, s61, 3
    s_mov_b32 m0, 139264
    s_lshl_b32 s55, s61, 12
    buffer_load_dwordx4 v1, s[12:15], s55 offen offset:0 lds
    buffer_load_dwordx4 v1, s[12:15], s55 offen offset:1024 lds
    buffer_load_dwordx4 v1, s[12:15], s55 offen offset:2048 lds
    buffer_load_dwordx4 v1, s[12:15], s55 offen offset:3072 lds
    s_lshl_b32 s55, s61, 8
    s_add_u32 m0, s65, 32768
    s_add_u32 s55, s55, s62
    buffer_load_dwordx4 v4, s[4:7], s55 offen offset:0 lds
    buffer_load_dwordx4 v5, s[4:7], s55 offen offset:1024 lds
    buffer_load_dwordx4 v6, s[4:7], s55 offen offset:2048 lds
    buffer_load_dwordx4 v7, s[4:7], s55 offen offset:3072 lds
    s_add_u32 s61, s61, 1
    s_and_b32 s61, s61, 3
    s_mov_b32 m0, 143360
    s_lshl_b32 s55, s61, 12
    buffer_load_dwordx4 v1, s[12:15], s55 offen offset:0 lds
    buffer_load_dwordx4 v1, s[12:15], s55 offen offset:1024 lds
    buffer_load_dwordx4 v1, s[12:15], s55 offen offset:2048 lds
    buffer_load_dwordx4 v1, s[12:15], s55 offen offset:3072 lds
    s_lshl_b32 s55, s61, 8
    s_add_u32 m0, s65, 49152
    s_add_u32 s55, s55, s62
    buffer_load_dwordx4 v4, s[4:7], s55 offen offset:0 lds
    buffer_load_dwordx4 v5, s[4:7], s55 offen offset:1024 lds
    buffer_load_dwordx4 v6, s[4:7], s55 offen offset:2048 lds
    buffer_load_dwordx4 v7, s[4:7], s55 offen offset:3072 lds
    s_barrier
    s_load_dwordx2 s[28:29], s[0:1], 48
    v_lshlrev_b32 v5, 8, v3
    v_lshl_or_b32 v5, v2, 3, v5
    v_add_u32 v5, 131072, v5
    v_lshl_or_b32 v12, v2, 8, v12
    v_add_u32 v12, s65, v12
    v_xor_b32 v13, 64, v12
    v_xor_b32 v14, 0x80, v12
    v_xor_b32 v15, 0xc0, v12
    v_mov_b32 v6, 162816
    s_getreg_b32 s61, hwreg(HW_REG_XCC_ID, 0, 4)
    v_mov_b32 v11, s61
    s_cmp_lt_u32 s52, 4
    s_cselect_b32 s63, -1, 0
    s_waitcnt vmcnt(24)
    ds_read_b64_tr_b16 v[128:129], v5 offset:0
    ds_read_b64_tr_b16 v[130:131], v5 offset:128
    ds_read_b128 v[64:67], v12 offset:0
    ds_read_b64_tr_b16 v[132:133], v5 offset:1024
    ds_read_b64_tr_b16 v[134:135], v5 offset:1152
    ds_read_b128 v[68:71], v13 offset:0
    ds_read_b64_tr_b16 v[136:137], v5 offset:2048
    ds_read_b64_tr_b16 v[138:139], v5 offset:2176
    ds_read_b128 v[72:75], v14 offset:0
    ds_read_b64_tr_b16 v[140:141], v5 offset:3072
    ds_read_b64_tr_b16 v[142:143], v5 offset:3200
    ds_read_b128 v[76:79], v15 offset:0
    s_waitcnt lgkmcnt(0)
    s_mul_i32 s53, s53, 0x9E3779B1
    s_add_u32 s53, s53, 0x7F4A7C15
    s_or_b32 s53, s53, 1
    s_cmp_lt_u32 s52, 4
    v_mov_b32 v10, s53
    s_mov_b64 exec, 1
    buffer_store_dwordx2 v[10:11], off, s[44:47], s57 sc1
    ds_write_b32 v6, v10
    s_mov_b64 exec, -1
    s_cbranch_scc0 L_KVv
    s_waitcnt vmcnt(17)
    ds_read_b64_tr_b16 v[144:145], v5 offset:4096
    ds_read_b64_tr_b16 v[146:147], v5 offset:4224
    ds_read_b128 v[80:83], v12 offset:16384
    s_waitcnt lgkmcnt(12)
    v_mfma_f32_16x16x32_bf16 v[192:195], v[128:131], v[64:67], 0
    ds_read_b64_tr_b16 v[148:149], v5 offset:5120
    ds_read_b64_tr_b16 v[150:151], v5 offset:5248
    ds_read_b128 v[84:87], v13 offset:16384
    s_waitcnt lgkmcnt(12)
    v_mfma_f32_16x16x32_bf16 v[192:195], v[132:135], v[68:71], v[192:195]
    ds_read_b64_tr_b16 v[152:153], v5 offset:6144
    ds_read_b64_tr_b16 v[154:155], v5 offset:6272
    ds_read_b128 v[88:91], v14 offset:16384
    s_waitcnt lgkmcnt(12)
    v_mfma_f32_16x16x32_bf16 v[192:195], v[136:139], v[72:75], v[192:195]
    ds_read_b64_tr_b16 v[156:157], v5 offset:7168
    ds_read_b64_tr_b16 v[158:159], v5 offset:7296
    ds_read_b128 v[92:95], v15 offset:16384
    s_waitcnt lgkmcnt(12)
    v_mfma_f32_16x16x32_bf16 v[192:195], v[140:143], v[76:79], v[192:195]
    s_waitcnt vmcnt(9)
    ds_read_b64_tr_b16 v[160:161], v5 offset:8192
    ds_read_b64_tr_b16 v[162:163], v5 offset:8320
    ds_read_b128 v[96:99], v12 offset:32768
    s_waitcnt lgkmcnt(12)
    v_mfma_f32_16x16x32_bf16 v[192:195], v[144:147], v[80:83], v[192:195]
    ds_read_b64_tr_b16 v[164:165], v5 offset:9216
    ds_read_b64_tr_b16 v[166:167], v5 offset:9344
    ds_read_b128 v[100:103], v13 offset:32768
    s_waitcnt lgkmcnt(12)
    v_mfma_f32_16x16x32_bf16 v[192:195], v[148:151], v[84:87], v[192:195]
    ds_read_b64_tr_b16 v[168:169], v5 offset:10240
    ds_read_b64_tr_b16 v[170:171], v5 offset:10368
    ds_read_b128 v[104:107], v14 offset:32768
    s_waitcnt lgkmcnt(12)
    v_mfma_f32_16x16x32_bf16 v[192:195], v[152:155], v[88:91], v[192:195]
    ds_read_b64_tr_b16 v[172:173], v5 offset:11264
    ds_read_b64_tr_b16 v[174:175], v5 offset:11392
    ds_read_b128 v[108:111], v15 offset:32768
    s_waitcnt lgkmcnt(12)
    v_mfma_f32_16x16x32_bf16 v[192:195], v[156:159], v[92:95], v[192:195]
    s_waitcnt vmcnt(1)
    ds_read_b64_tr_b16 v[176:177], v5 offset:12288
    ds_read_b64_tr_b16 v[178:179], v5 offset:12416
    ds_read_b128 v[112:115], v12 offset:49152
    s_waitcnt lgkmcnt(12)
    v_mfma_f32_16x16x32_bf16 v[192:195], v[160:163], v[96:99], v[192:195]
    ds_read_b64_tr_b16 v[180:181], v5 offset:13312
    ds_read_b64_tr_b16 v[182:183], v5 offset:13440
    ds_read_b128 v[116:119], v13 offset:49152
    s_waitcnt lgkmcnt(12)
    v_mfma_f32_16x16x32_bf16 v[192:195], v[164:167], v[100:103], v[192:195]
    ds_read_b64_tr_b16 v[184:185], v5 offset:14336
    ds_read_b64_tr_b16 v[186:187], v5 offset:14464
    ds_read_b128 v[120:123], v14 offset:49152
    s_waitcnt lgkmcnt(12)
    v_mfma_f32_16x16x32_bf16 v[192:195], v[168:171], v[104:107], v[192:195]
    ds_read_b64_tr_b16 v[188:189], v5 offset:15360
    ds_read_b64_tr_b16 v[190:191], v5 offset:15488
    ds_read_b128 v[124:127], v15 offset:49152
    s_waitcnt lgkmcnt(12)
    v_mfma_f32_16x16x32_bf16 v[192:195], v[172:175], v[108:111], v[192:195]
    s_waitcnt lgkmcnt(9)
    v_mfma_f32_16x16x32_bf16 v[192:195], v[176:179], v[112:115], v[192:195]
    s_waitcnt lgkmcnt(6)
    v_mfma_f32_16x16x32_bf16 v[192:195], v[180:183], v[116:119], v[192:195]
    s_waitcnt lgkmcnt(3)
    v_mfma_f32_16x16x32_bf16 v[192:195], v[184:187], v[120:123], v[192:195]
    s_waitcnt lgkmcnt(0)
    v_mfma_f32_16x16x32_bf16 v[192:195], v[188:191], v[124:127], v[192:195]
    s_branch L_KVd
L_KVv:
    s_waitcnt vmcnt(17)
    ds_read_b64_tr_b16 v[144:145], v5 offset:4096
    ds_read_b64_tr_b16 v[146:147], v5 offset:4224
    ds_read_b128 v[80:83], v12 offset:16384
    s_waitcnt lgkmcnt(12)
    v_mfma_f32_16x16x32_bf16 v[192:195], v[64:67], v[128:131], 0
    ds_read_b64_tr_b16 v[148:149], v5 offset:5120
    ds_read_b64_tr_b16 v[150:151], v5 offset:5248
    ds_read_b128 v[84:87], v13 offset:16384
    s_waitcnt lgkmcnt(12)
    v_mfma_f32_16x16x32_bf16 v[192:195], v[68:71], v[132:135], v[192:195]
    ds_read_b64_tr_b16 v[152:153], v5 offset:6144
    ds_read_b64_tr_b16 v[154:155], v5 offset:6272
    ds_read_b128 v[88:91], v14 offset:16384
    s_waitcnt lgkmcnt(12)
    v_mfma_f32_16x16x32_bf16 v[192:195], v[72:75], v[136:139], v[192:195]
    ds_read_b64_tr_b16 v[156:157], v5 offset:7168
    ds_read_b64_tr_b16 v[158:159], v5 offset:7296
    ds_read_b128 v[92:95], v15 offset:16384
    s_waitcnt lgkmcnt(12)
    v_mfma_f32_16x16x32_bf16 v[192:195], v[76:79], v[140:143], v[192:195]
    s_waitcnt vmcnt(9)
    ds_read_b64_tr_b16 v[160:161], v5 offset:8192
    ds_read_b64_tr_b16 v[162:163], v5 offset:8320
    ds_read_b128 v[96:99], v12 offset:32768
    s_waitcnt lgkmcnt(12)
    v_mfma_f32_16x16x32_bf16 v[192:195], v[80:83], v[144:147], v[192:195]
    ds_read_b64_tr_b16 v[164:165], v5 offset:9216
    ds_read_b64_tr_b16 v[166:167], v5 offset:9344
    ds_read_b128 v[100:103], v13 offset:32768
    s_waitcnt lgkmcnt(12)
    v_mfma_f32_16x16x32_bf16 v[192:195], v[84:87], v[148:151], v[192:195]
    ds_read_b64_tr_b16 v[168:169], v5 offset:10240
    ds_read_b64_tr_b16 v[170:171], v5 offset:10368
    ds_read_b128 v[104:107], v14 offset:32768
    s_waitcnt lgkmcnt(12)
    v_mfma_f32_16x16x32_bf16 v[192:195], v[88:91], v[152:155], v[192:195]
    ds_read_b64_tr_b16 v[172:173], v5 offset:11264
    ds_read_b64_tr_b16 v[174:175], v5 offset:11392
    ds_read_b128 v[108:111], v15 offset:32768
    s_waitcnt lgkmcnt(12)
    v_mfma_f32_16x16x32_bf16 v[192:195], v[92:95], v[156:159], v[192:195]
    s_waitcnt vmcnt(1)
    ds_read_b64_tr_b16 v[176:177], v5 offset:12288
    ds_read_b64_tr_b16 v[178:179], v5 offset:12416
    ds_read_b128 v[112:115], v12 offset:49152
    s_waitcnt lgkmcnt(12)
    v_mfma_f32_16x16x32_bf16 v[192:195], v[96:99], v[160:163], v[192:195]
    ds_read_b64_tr_b16 v[180:181], v5 offset:13312
    ds_read_b64_tr_b16 v[182:183], v5 offset:13440
    ds_read_b128 v[116:119], v13 offset:49152
    s_waitcnt lgkmcnt(12)
    v_mfma_f32_16x16x32_bf16 v[192:195], v[100:103], v[164:167], v[192:195]
    ds_read_b64_tr_b16 v[184:185], v5 offset:14336
    ds_read_b64_tr_b16 v[186:187], v5 offset:14464
    ds_read_b128 v[120:123], v14 offset:49152
    s_waitcnt lgkmcnt(12)
    v_mfma_f32_16x16x32_bf16 v[192:195], v[104:107], v[168:171], v[192:195]
    ds_read_b64_tr_b16 v[188:189], v5 offset:15360
    ds_read_b64_tr_b16 v[190:191], v5 offset:15488
    ds_read_b128 v[124:127], v15 offset:49152
    s_waitcnt lgkmcnt(12)
    v_mfma_f32_16x16x32_bf16 v[192:195], v[108:111], v[172:175], v[192:195]
    s_waitcnt lgkmcnt(9)
    v_mfma_f32_16x16x32_bf16 v[192:195], v[112:115], v[176:179], v[192:195]
    s_waitcnt lgkmcnt(6)
    v_mfma_f32_16x16x32_bf16 v[192:195], v[116:119], v[180:183], v[192:195]
    s_waitcnt lgkmcnt(3)
    v_mfma_f32_16x16x32_bf16 v[192:195], v[120:123], v[184:187], v[192:195]
    s_waitcnt lgkmcnt(0)
    v_mfma_f32_16x16x32_bf16 v[192:195], v[124:127], v[188:191], v[192:195]
L_KVd:
    s_cmp_lt_u32 s52, 4
    s_cselect_b32 s61, 1052289595, 1.0
    s_nop 5
    v_mul_f32 v192, s61, v192
    v_mul_f32 v193, s61, v193
    v_mul_f32 v194, s61, v194
    v_mul_f32 v195, s61, v195
    v_cvt_pk_bf16_f32 v196, v192, v193
    v_cvt_pk_bf16_f32 v197, v194, v195
    v_min_u32 v196, -2, v196
    v_min_u32 v197, -2, v197
    buffer_store_dwordx2 v[196:197], v8, s[44:47], s54 offen sc1
    v_mul_f32 v8, v192, v192
    v_fmac_f32 v8, v193, v193
    v_fmac_f32 v8, v194, v194
    v_fmac_f32 v8, v195, v195
    v_mov_b32 v9, v8
    s_nop 1
    v_permlane32_swap_b32 v8, v9
    v_add_f32 v8, v8, v9
    v_mov_b32 v9, v8
    s_nop 1
    v_permlane16_swap_b32 v8, v9
    v_add_f32 v8, v8, v9
    s_nop 1
    v_max_u32_dpp v8, v8, v8 row_ror:8 row_mask:0xf bank_mask:0xf
    s_nop 1
    v_max_u32_dpp v8, v8, v8 row_ror:4 row_mask:0xf bank_mask:0xf
    s_nop 1
    v_max_u32_dpp v8, v8, v8 row_ror:2 row_mask:0xf bank_mask:0xf
    s_nop 1
    v_max_u32_dpp v9, v8, v8 row_ror:1 row_mask:0xf bank_mask:0xf
    s_mov_b64 exec, 1
    v_and_b32 v11, s63, v9
    buffer_store_dwordx2 v[10:11], off, s[44:47], s58 sc1
    s_mov_b64 exec, -1
    s_setprio 0
    s_barrier
    s_mul_i32 s59, s2, 7168
    s_add_u32 s36, s28, s59
    s_addc_u32 s37, s29, 0
    s_load_dword s56, s[36:37], 6720
    s_load_dword s56, s[36:37], 6784
    s_load_dword s56, s[36:37], 6848
    s_load_dword s56, s[36:37], 6912
    s_load_dword s56, s[36:37], 6976
    s_load_dword s56, s[36:37], 7040
    s_load_dword s56, s[36:37], 7104
    s_load_dwordx2 s[20:21], s[0:1], 48
    s_load_dwordx2 s[16:17], s[0:1], 32
    s_load_dwordx2 s[28:29], s[0:1], 64
    s_load_dwordx2 s[40:41], s[0:1], 88
    s_mov_b32 s22, 1835008
    s_mov_b32 s23, 0x00020000
    s_mov_b32 s18, 524288
    s_mov_b32 s19, 0x00020000
    s_mov_b32 s30, 1835008
    s_mov_b32 s31, 0x00020000
    s_mov_b32 s42, 2097152
    s_mov_b32 s43, 0x00020000
    s_barrier
    s_barrier
    s_barrier
    s_barrier
    s_setprio 1
    s_call_b64 s[38:39], L_gsetup
    s_call_b64 s[38:39], L_gsetup2
    s_branch L_Gjoin
L_nKV:
    s_load_dwordx2 s[28:29], s[0:1], 48
    s_mov_b32 s46, 16777216
    s_mov_b32 s47, s63
    s_cmp_lt_u32 s50, 4
    s_cbranch_scc1 L_A1
    s_cmp_eq_u32 s50, 5
    s_cbranch_scc1 L_G5
    s_cmp_eq_u32 s50, 6
    s_cbranch_scc1 L_G6
    s_lshl_b32 s61, s51, 16
    s_add_u32 s33, s60, 1
    s_and_b32 s33, s33, 3
    s_lshl_b32 s57, s33, 14
    s_add_u32 s57, s57, s61
    s_lshl_b32 s33, s33, 12
    s_add_u32 s34, s60, 2
    s_and_b32 s34, s34, 3
    s_lshl_b32 s58, s34, 14
    s_add_u32 s58, s58, s61
    s_lshl_b32 s34, s34, 12
    s_add_u32 s35, s60, 3
    s_and_b32 s35, s35, 3
    s_lshl_b32 s59, s35, 14
    s_add_u32 s59, s59, s61
    s_lshl_b32 s35, s35, 12
    s_waitcnt lgkmcnt(0)
    s_barrier
    s_add_u32 s55, s3, 0
    s_and_b32 s55, s55, 3
    s_lshl_b32 s55, s55, 8
    s_add_u32 m0, s33, 0
    s_add_u32 s60, s57, s55
    buffer_load_dwordx4 v4, s[4:7], s60 offen offset:0 lds
    buffer_load_dwordx4 v5, s[4:7], s60 offen offset:1024 lds
    buffer_load_dwordx4 v6, s[4:7], s60 offen offset:2048 lds
    buffer_load_dwordx4 v7, s[4:7], s60 offen offset:3072 lds
    s_add_u32 m0, s34, 0
    s_add_u32 s60, s58, s55
    buffer_load_dwordx4 v4, s[4:7], s60 offen offset:0 lds
    buffer_load_dwordx4 v5, s[4:7], s60 offen offset:1024 lds
    buffer_load_dwordx4 v6, s[4:7], s60 offen offset:2048 lds
    buffer_load_dwordx4 v7, s[4:7], s60 offen offset:3072 lds
    s_add_u32 m0, s35, 0
    s_add_u32 s60, s59, s55
    buffer_load_dwordx4 v4, s[4:7], s60 offen offset:0 lds
    buffer_load_dwordx4 v5, s[4:7], s60 offen offset:1024 lds
    buffer_load_dwordx4 v6, s[4:7], s60 offen offset:2048 lds
    buffer_load_dwordx4 v7, s[4:7], s60 offen offset:3072 lds
    s_add_u32 s55, s3, 1
    s_and_b32 s55, s55, 3
    s_lshl_b32 s55, s55, 8
    s_add_u32 m0, s33, 16384
    s_add_u32 s60, s57, s55
    buffer_load_dwordx4 v4, s[4:7], s60 offen offset:0 lds
    buffer_load_dwordx4 v5, s[4:7], s60 offen offset:1024 lds
    buffer_load_dwordx4 v6, s[4:7], s60 offen offset:2048 lds
    buffer_load_dwordx4 v7, s[4:7], s60 offen offset:3072 lds
    s_add_u32 m0, s34, 16384
    s_add_u32 s60, s58, s55
    buffer_load_dwordx4 v4, s[4:7], s60 offen offset:0 lds
    buffer_load_dwordx4 v5, s[4:7], s60 offen offset:1024 lds
    buffer_load_dwordx4 v6, s[4:7], s60 offen offset:2048 lds
    buffer_load_dwordx4 v7, s[4:7], s60 offen offset:3072 lds
    s_add_u32 m0, s35, 16384
    s_add_u32 s60, s59, s55
    buffer_load_dwordx4 v4, s[4:7], s60 offen offset:0 lds
    buffer_load_dwordx4 v5, s[4:7], s60 offen offset:1024 lds
    buffer_load_dwordx4 v6, s[4:7], s60 offen offset:2048 lds
    buffer_load_dwordx4 v7, s[4:7], s60 offen offset:3072 lds
    s_add_u32 s55, s3, 2
    s_and_b32 s55, s55, 3
    s_lshl_b32 s55, s55, 8
    s_add_u32 m0, s33, 32768
    s_add_u32 s60, s57, s55
    buffer_load_dwordx4 v4, s[4:7], s60 offen offset:0 lds
    buffer_load_dwordx4 v5, s[4:7], s60 offen offset:1024 lds
    buffer_load_dwordx4 v6, s[4:7], s60 offen offset:2048 lds
    buffer_load_dwordx4 v7, s[4:7], s60 offen offset:3072 lds
    s_add_u32 m0, s34, 32768
    s_add_u32 s60, s58, s55
    buffer_load_dwordx4 v4, s[4:7], s60 offen offset:0 lds
    buffer_load_dwordx4 v5, s[4:7], s60 offen offset:1024 lds
    buffer_load_dwordx4 v6, s[4:7], s60 offen offset:2048 lds
    buffer_load_dwordx4 v7, s[4:7], s60 offen offset:3072 lds
    s_add_u32 m0, s35, 32768
    s_add_u32 s60, s59, s55
    buffer_load_dwordx4 v4, s[4:7], s60 offen offset:0 lds
    buffer_load_dwordx4 v5, s[4:7], s60 offen offset:1024 lds
    buffer_load_dwordx4 v6, s[4:7], s60 offen offset:2048 lds
    buffer_load_dwordx4 v7, s[4:7], s60 offen offset:3072 lds
    s_waitcnt vmcnt(24)
    s_barrier
    s_add_u32 s55, s3, 3
    s_and_b32 s55, s55, 3
    s_lshl_b32 s55, s55, 8
    s_add_u32 m0, s33, 49152
    s_add_u32 s60, s57, s55
    buffer_load_dwordx4 v4, s[4:7], s60 offen offset:0 lds
    buffer_load_dwordx4 v5, s[4:7], s60 offen offset:1024 lds
    buffer_load_dwordx4 v6, s[4:7], s60 offen offset:2048 lds
    buffer_load_dwordx4 v7, s[4:7], s60 offen offset:3072 lds
    s_add_u32 m0, s34, 49152
    s_add_u32 s60, s58, s55
    buffer_load_dwordx4 v4, s[4:7], s60 offen offset:0 lds
    buffer_load_dwordx4 v5, s[4:7], s60 offen offset:1024 lds
    buffer_load_dwordx4 v6, s[4:7], s60 offen offset:2048 lds
    buffer_load_dwordx4 v7, s[4:7], s60 offen offset:3072 lds
    s_add_u32 m0, s35, 49152
    s_add_u32 s60, s59, s55
    buffer_load_dwordx4 v4, s[4:7], s60 offen offset:0 lds
    buffer_load_dwordx4 v5, s[4:7], s60 offen offset:1024 lds
    buffer_load_dwordx4 v6, s[4:7], s60 offen offset:2048 lds
    buffer_load_dwordx4 v7, s[4:7], s60 offen offset:3072 lds
    s_mul_i32 s59, s2, 7168
    s_add_u32 s36, s28, s59
    s_addc_u32 s37, s29, 0
    s_load_dword s56, s[36:37], 5824
    s_load_dword s56, s[36:37], 5888
    s_load_dword s56, s[36:37], 5952
    s_load_dword s56, s[36:37], 6016
    s_load_dword s56, s[36:37], 6080
    s_load_dword s56, s[36:37], 6144
    s_load_dword s56, s[36:37], 6208
    s_load_dwordx2 s[20:21], s[0:1], 48
    s_load_dwordx2 s[16:17], s[0:1], 32
    s_load_dwordx2 s[28:29], s[0:1], 64
    s_load_dwordx2 s[40:41], s[0:1], 88
    s_mov_b32 s22, 1835008
    s_mov_b32 s23, 0x00020000
    s_mov_b32 s18, 524288
    s_mov_b32 s19, 0x00020000
    s_mov_b32 s30, 1835008
    s_mov_b32 s31, 0x00020000
    s_mov_b32 s42, 2097152
    s_mov_b32 s43, 0x00020000
    s_waitcnt vmcnt(24)
    s_barrier
    s_waitcnt vmcnt(12)
    s_barrier
    s_waitcnt vmcnt(0)
    s_barrier
    s_barrier
    s_setprio 1
    s_call_b64 s[38:39], L_gsetup
    s_call_b64 s[38:39], L_gsetup2
    s_branch L_Gjoin
L_G5:
    s_mov_b32 s10, 524288
    s_mov_b32 s11, 0x00020000
    v_lshrrev_b32 v1, 3, v255
    v_and_b32 v2, 7, v255
    v_bfe_u32 v3, v255, 4, 1
    v_lshlrev_b32 v3, 2, v3
    v_xor_b32 v2, v3, v2
    v_lshlrev_b32 v2, 4, v2
    v_lshl_or_b32 v8, v1, 10, v2
    v_add_u32 v9, 7168, v8
    v_add_u32 v10, 14336, v8
    v_add_u32 v11, 21504, v8
    s_lshl_b32 s64, s52, 7
    s_waitcnt lgkmcnt(0)
    s_barrier
    s_add_u32 s55, s3, 0
    s_and_b32 s55, s55, 3
    s_lshl_b32 s55, s55, 17
    s_add_u32 s55, s55, s64
    s_mov_b32 m0, 65536
    s_nop 0
    buffer_load_dwordx4 v8, s[8:11], s55 offen offset:0 lds
    buffer_load_dwordx4 v9, s[8:11], s55 offen offset:1024 lds
    buffer_load_dwordx4 v10, s[8:11], s55 offen offset:2048 lds
    buffer_load_dwordx4 v11, s[8:11], s55 offen offset:3072 lds
    s_mov_b32 m0, 69632
    s_add_u32 s55, s55, 32768
    buffer_load_dwordx4 v8, s[8:11], s55 offen offset:0 lds
    buffer_load_dwordx4 v9, s[8:11], s55 offen offset:1024 lds
    buffer_load_dwordx4 v10, s[8:11], s55 offen offset:2048 lds
    buffer_load_dwordx4 v11, s[8:11], s55 offen offset:3072 lds
    s_mov_b32 m0, 73728
    s_add_u32 s55, s55, 32768
    buffer_load_dwordx4 v8, s[8:11], s55 offen offset:0 lds
    buffer_load_dwordx4 v9, s[8:11], s55 offen offset:1024 lds
    buffer_load_dwordx4 v10, s[8:11], s55 offen offset:2048 lds
    buffer_load_dwordx4 v11, s[8:11], s55 offen offset:3072 lds
    s_mov_b32 m0, 77824
    s_add_u32 s55, s55, 32768
    buffer_load_dwordx4 v8, s[8:11], s55 offen offset:0 lds
    buffer_load_dwordx4 v9, s[8:11], s55 offen offset:1024 lds
    buffer_load_dwordx4 v10, s[8:11], s55 offen offset:2048 lds
    buffer_load_dwordx4 v11, s[8:11], s55 offen offset:3072 lds
    s_add_u32 s55, s3, 1
    s_and_b32 s55, s55, 3
    s_lshl_b32 s55, s55, 17
    s_add_u32 s55, s55, s64
    s_mov_b32 m0, 81920
    s_nop 0
    buffer_load_dwordx4 v8, s[8:11], s55 offen offset:0 lds
    buffer_load_dwordx4 v9, s[8:11], s55 offen offset:1024 lds
    buffer_load_dwordx4 v10, s[8:11], s55 offen offset:2048 lds
    buffer_load_dwordx4 v11, s[8:11], s55 offen offset:3072 lds
    s_mov_b32 m0, 86016
    s_add_u32 s55, s55, 32768
    buffer_load_dwordx4 v8, s[8:11], s55 offen offset:0 lds
    buffer_load_dwordx4 v9, s[8:11], s55 offen offset:1024 lds
    buffer_load_dwordx4 v10, s[8:11], s55 offen offset:2048 lds
    buffer_load_dwordx4 v11, s[8:11], s55 offen offset:3072 lds
    s_mov_b32 m0, 90112
    s_add_u32 s55, s55, 32768
    buffer_load_dwordx4 v8, s[8:11], s55 offen offset:0 lds
    buffer_load_dwordx4 v9, s[8:11], s55 offen offset:1024 lds
    buffer_load_dwordx4 v10, s[8:11], s55 offen offset:2048 lds
    buffer_load_dwordx4 v11, s[8:11], s55 offen offset:3072 lds
    s_mov_b32 m0, 94208
    s_add_u32 s55, s55, 32768
    buffer_load_dwordx4 v8, s[8:11], s55 offen offset:0 lds
    buffer_load_dwordx4 v9, s[8:11], s55 offen offset:1024 lds
    buffer_load_dwordx4 v10, s[8:11], s55 offen offset:2048 lds
    buffer_load_dwordx4 v11, s[8:11], s55 offen offset:3072 lds
    s_add_u32 s55, s3, 2
    s_and_b32 s55, s55, 3
    s_lshl_b32 s55, s55, 17
    s_add_u32 s55, s55, s64
    s_mov_b32 m0, 98304
    s_nop 0
    buffer_load_dwordx4 v8, s[8:11], s55 offen offset:0 lds
    buffer_load_dwordx4 v9, s[8:11], s55 offen offset:1024 lds
    buffer_load_dwordx4 v10, s[8:11], s55 offen offset:2048 lds
    buffer_load_dwordx4 v11, s[8:11], s55 offen offset:3072 lds
    s_mov_b32 m0, 102400
    s_add_u32 s55, s55, 32768
    buffer_load_dwordx4 v8, s[8:11], s55 offen offset:0 lds
    buffer_load_dwordx4 v9, s[8:11], s55 offen offset:1024 lds
    buffer_load_dwordx4 v10, s[8:11], s55 offen offset:2048 lds
    buffer_load_dwordx4 v11, s[8:11], s55 offen offset:3072 lds
    s_mov_b32 m0, 106496
    s_add_u32 s55, s55, 32768
    buffer_load_dwordx4 v8, s[8:11], s55 offen offset:0 lds
    buffer_load_dwordx4 v9, s[8:11], s55 offen offset:1024 lds
    buffer_load_dwordx4 v10, s[8:11], s55 offen offset:2048 lds
    buffer_load_dwordx4 v11, s[8:11], s55 offen offset:3072 lds
    s_mov_b32 m0, 110592
    s_add_u32 s55, s55, 32768
    buffer_load_dwordx4 v8, s[8:11], s55 offen offset:0 lds
    buffer_load_dwordx4 v9, s[8:11], s55 offen offset:1024 lds
    buffer_load_dwordx4 v10, s[8:11], s55 offen offset:2048 lds
    buffer_load_dwordx4 v11, s[8:11], s55 offen offset:3072 lds
    s_waitcnt vmcnt(32)
    s_barrier
    s_add_u32 s55, s3, 3
    s_and_b32 s55, s55, 3
    s_lshl_b32 s55, s55, 17
    s_add_u32 s55, s55, s64
    s_mov_b32 m0, 114688
    s_nop 0
    buffer_load_dwordx4 v8, s[8:11], s55 offen offset:0 lds
    buffer_load_dwordx4 v9, s[8:11], s55 offen offset:1024 lds
    buffer_load_dwordx4 v10, s[8:11], s55 offen offset:2048 lds
    buffer_load_dwordx4 v11, s[8:11], s55 offen offset:3072 lds
    s_mov_b32 m0, 118784
    s_add_u32 s55, s55, 32768
    buffer_load_dwordx4 v8, s[8:11], s55 offen offset:0 lds
    buffer_load_dwordx4 v9, s[8:11], s55 offen offset:1024 lds
    buffer_load_dwordx4 v10, s[8:11], s55 offen offset:2048 lds
    buffer_load_dwordx4 v11, s[8:11], s55 offen offset:3072 lds
    s_mov_b32 m0, 122880
    s_add_u32 s55, s55, 32768
    buffer_load_dwordx4 v8, s[8:11], s55 offen offset:0 lds
    buffer_load_dwordx4 v9, s[8:11], s55 offen offset:1024 lds
    buffer_load_dwordx4 v10, s[8:11], s55 offen offset:2048 lds
    buffer_load_dwordx4 v11, s[8:11], s55 offen offset:3072 lds
    s_mov_b32 m0, 126976
    s_add_u32 s55, s55, 32768
    buffer_load_dwordx4 v8, s[8:11], s55 offen offset:0 lds
    buffer_load_dwordx4 v9, s[8:11], s55 offen offset:1024 lds
    buffer_load_dwordx4 v10, s[8:11], s55 offen offset:2048 lds
    buffer_load_dwordx4 v11, s[8:11], s55 offen offset:3072 lds
    s_mul_i32 s59, s2, 7168
    s_add_u32 s36, s28, s59
    s_addc_u32 s37, s29, 0
    s_load_dword s56, s[36:37], 6272
    s_load_dword s56, s[36:37], 6336
    s_load_dword s56, s[36:37], 6400
    s_load_dword s56, s[36:37], 6464
    s_load_dword s56, s[36:37], 6528
    s_load_dword s56, s[36:37], 6592
    s_load_dword s56, s[36:37], 6656
    s_load_dwordx2 s[20:21], s[0:1], 48
    s_load_dwordx2 s[16:17], s[0:1], 32
    s_load_dwordx2 s[28:29], s[0:1], 64
    s_load_dwordx2 s[40:41], s[0:1], 88
    s_mov_b32 s22, 1835008
    s_mov_b32 s23, 0x00020000
    s_mov_b32 s18, 524288
    s_mov_b32 s19, 0x00020000
    s_mov_b32 s30, 1835008
    s_mov_b32 s31, 0x00020000
    s_mov_b32 s42, 2097152
    s_mov_b32 s43, 0x00020000
    s_waitcnt vmcnt(32)
    s_barrier
    s_waitcnt vmcnt(16)
    s_barrier
    s_waitcnt vmcnt(0)
    s_barrier
    s_barrier
    s_setprio 1
    s_call_b64 s[38:39], L_gsetup
    s_call_b64 s[38:39], L_gsetup2
    s_branch L_Gjoin
L_G6:
    s_load_dwordx2 s[24:25], s[0:1], 56
    s_load_dwordx2 s[32:33], s[0:1], 72
    s_load_dwordx2 s[36:37], s[0:1], 80
    s_lshl_b32 s60, s52, 7
    s_waitcnt lgkmcnt(0)
    s_barrier
    s_mul_i32 s61, s2, 7168
    s_add_u32 s61, s61, 3584
    s_add_u32 s64, s28, s61
    s_addc_u32 s65, s29, 0
    s_mov_b32 s26, 3584
    s_mov_b32 s27, 0x00020000
    s_mov_b32 s34, 1024
    s_mov_b32 s35, 0x00020000
    s_mov_b32 s38, 1024
    s_mov_b32 s39, 0x00020000
    v_mov_b32 v4, 0
    v_mov_b32 v5, 0
    v_mov_b32 v6, 0
    v_mov_b32 v7, 0
    v_lshlrev_b32 v16, 4, v255
    v_add_u32 v2, 159744, v16
    v_mov_b32 v8, 0xff800000
    v_mov_b32 v9, v8
    v_mov_b32 v10, v8
    v_mov_b32 v11, v8
    ds_write_b128 v2, v[4:7]
    ds_write_b128 v2, v[8:11] offset:1024
    v_add_u32 v2, 150528, v16
    ds_write_b128 v2, v[4:7]
    s_lshl_b32 s57, s3, 4
    s_mul_i32 s61, s52, 448
    s_mov_b32 m0, 161792
    s_waitcnt lgkmcnt(0)
    s_load_dword s56, s[64:65], 0
    s_load_dword s56, s[64:65], 64
    s_load_dword s56, s[64:65], 128
    s_load_dword s56, s[64:65], 192
    s_load_dword s56, s[64:65], 256
    s_load_dword s56, s[64:65], 320
    s_load_dword s56, s[64:65], 384
    s_load_dword s56, s[64:65], 448
    s_load_dword s56, s[64:65], 512
    s_load_dword s56, s[64:65], 576
    s_load_dword s56, s[64:65], 640
    s_load_dword s56, s[64:65], 704
    s_load_dword s56, s[64:65], 768
    s_load_dword s56, s[64:65], 832
    s_call_b64 s[58:59], L_gsetupx
    v_add_u32 v1, s57, v255
    v_and_b32 v1, 63, v1
    v_lshlrev_b32 v1, 4, v1
    s_barrier
    buffer_load_dwordx4 v1, s[36:39], 0 offen lds
    s_mov_b32 m0, 162880
    s_mov_b64 exec, 0xfffffff
    buffer_load_dwordx4 v16, s[24:27], s61 offen lds
    s_mov_b32 m0, 163328
    s_mov_b64 exec, 0xff
    buffer_load_dwordx4 v16, s[32:35], s60 offen lds
    s_mov_b64 exec, -1
    s_load_dword s56, s[64:65], 896
    s_load_dword s56, s[64:65], 960
    s_load_dword s56, s[64:65], 1024
    s_load_dword s56, s[64:65], 1088
    s_load_dword s56, s[64:65], 1152
    s_load_dword s56, s[64:65], 1216
    s_load_dword s56, s[64:65], 1280
    s_load_dword s56, s[64:65], 1344
    s_load_dword s56, s[64:65], 1408
    s_load_dword s56, s[64:65], 1472
    s_load_dword s56, s[64:65], 1536
    s_load_dword s56, s[64:65], 1600
    s_load_dword s56, s[64:65], 1664
    s_load_dword s56, s[64:65], 1728
    s_barrier
    s_barrier
    s_load_dwordx2 s[20:21], s[0:1], 48
    s_load_dwordx2 s[16:17], s[0:1], 32
    s_load_dwordx2 s[28:29], s[0:1], 64
    s_load_dwordx2 s[40:41], s[0:1], 88
    s_mov_b32 s22, 1835008
    s_mov_b32 s23, 0x00020000
    s_mov_b32 s18, 524288
    s_mov_b32 s19, 0x00020000
    s_mov_b32 s30, 1835008
    s_mov_b32 s31, 0x00020000
    s_mov_b32 s42, 2097152
    s_mov_b32 s43, 0x00020000
    s_load_dword s56, s[64:65], 1792
    s_load_dword s56, s[64:65], 1856
    s_load_dword s56, s[64:65], 1920
    s_load_dword s56, s[64:65], 1984
    s_load_dword s56, s[64:65], 2048
    s_load_dword s56, s[64:65], 2112
    s_load_dword s56, s[64:65], 2176
    s_waitcnt vmcnt(0)
    s_barrier
    s_barrier
    s_branch L_Gjoin
L_A1:
    s_cmp_eq_u32 s50, 1
    s_cbranch_scc0 L_A1b
    v_lshlrev_b32 v2, 7, v255
    s_getpc_b64 s[16:17]
L_pc:
    s_mov_b32 s18, L_end - L_pc
    s_mov_b32 s19, 0x00020000
    s_lshr_b32 s57, s2, 3
    s_mul_i32 s57, s57, 1152
    s_mov_b64 exec, 0x1ff
    buffer_load_dword v197, v2, s[16:19], s57 offen
    s_mov_b64 exec, -1
L_A1b:
    s_waitcnt lgkmcnt(0)
    s_barrier
    s_mul_i32 s61, s50, 896
    s_mul_i32 s60, s2, 7168
    s_add_u32 s60, s60, s61
    s_add_u32 s28, s28, s60
    s_addc_u32 s29, s29, 0
    s_load_dword s56, s[28:29], 0
    s_load_dword s56, s[28:29], 64
    s_load_dword s56, s[28:29], 128
    s_load_dword s56, s[28:29], 192
    s_load_dword s56, s[28:29], 256
    s_load_dword s56, s[28:29], 320
    s_load_dword s56, s[28:29], 384
    s_load_dword s56, s[28:29], 448
    s_load_dword s56, s[28:29], 512
    s_load_dword s56, s[28:29], 576
    s_load_dword s56, s[28:29], 640
    s_load_dword s56, s[28:29], 704
    s_load_dword s56, s[28:29], 768
    s_load_dword s56, s[28:29], 832
    s_lshr_b32 s60, s50, 1
    s_lshl_b32 s60, s60, 13
    v_and_b32 v1, 31, v255
    v_lshrrev_b32 v2, 5, v255
    v_and_b32 v3, 15, v255
    v_xor_b32 v3, v2, v3
    v_lshlrev_b32 v3, 4, v3
    v_lshl_or_b32 v168, v1, 8, v3
    v_add_u32 v168, s60, v168
    s_mov_b64 s[12:13], s[44:45]
    s_mov_b32 s15, 0x00020000
    v_xor_b32 v169, 32, v168
    v_xor_b32 v170, 64, v168
    v_xor_b32 v171, 96, v168
    v_xor_b32 v176, 128, v168
    v_xor_b32 v177, 160, v168
    v_xor_b32 v178, 192, v168
    v_xor_b32 v179, 224, v168
    v_lshrrev_b32 v1, 5, v255
    v_bfe_u32 v2, v255, 2, 2
    v_mad_u32_u24 v1, v1, 8, v2
    v_lshlrev_b32 v1, 7, v1
    v_bfe_u32 v2, v255, 3, 1
    v_lshl_or_b32 v1, v2, 6, v1
    v_bfe_u32 v2, v255, 4, 1
    v_lshl_or_b32 v1, v2, 5, v1
    v_and_b32 v2, 3, v255
    v_lshl_or_b32 v184, v2, 3, v1
    s_and_b32 s60, s50, 1
    s_lshl_b32 s60, s60, 6
    v_xor_b32 v184, s60, v184
    v_add_u32 v184, 65536, v184
    v_and_b32 v1, 11, v255
    v_cmp_eq_u32 vcc, 0, v1
    v_mov_b32 v2, 0x3f803f80
    v_lshlrev_b32 v250, 4, v255
    v_cndmask_b32 v68, 0, v2, vcc
    v_mov_b32 v251, 160000
    v_mov_b32 v69, v68
    v_lshlrev_b32 v247, 5, v255
    s_lshl_b32 s60, s50, 8
    s_add_u32 s60, s60, 131072
    v_lshlrev_b32 v244, 2, v255
    v_add_u32 v244, s60, v244
    v_add_u32 v246, 151552, v250
    v_add_u32 v252, 65536, v250
    s_lshr_b32 s60, s50, 1
    s_lshl_b32 s60, s60, 12
    s_and_b32 s61, s50, 1
    s_lshl_b32 s61, s61, 11
    s_add_u32 s60, s60, s61
    v_add_u32 v220, s60, v246
    s_lshl_b32 s60, s50, 11
    s_add_u32 s61, s60, 16384
    s_add_u32 s60, s60, 4096
    s_lshl_b32 s54, s50, 14
    s_add_u32 s54, s54, 524288
    s_and_b32 s55, s52, 3
    s_lshl_b32 s55, s55, 12
    s_mov_b32 s63, 0
    s_add_u32 s8, s54, s55
    s_add_u32 s55, s55, 4096
    s_and_b32 s55, s55, 0x3fff
    s_add_u32 s9, s54, s55
    s_add_u32 s55, s55, 4096
    s_and_b32 s55, s55, 0x3fff
    s_add_u32 s10, s54, s55
    s_add_u32 s55, s55, 4096
    s_and_b32 s55, s55, 0x3fff
    s_add_u32 s11, s54, s55
    v_mov_b64 v[70:71], v[68:69]
    v_mov_b64 v[76:77], v[68:69]
    v_mov_b64 v[78:79], v[68:69]
    v_mov_b64 v[84:85], v[68:69]
    v_mov_b64 v[86:87], v[68:69]
    v_mov_b64 v[92:93], v[68:69]
    v_mov_b64 v[94:95], v[68:69]
    v_mov_b64 v[100:101], v[68:69]
    v_mov_b64 v[102:103], v[68:69]
    v_mov_b64 v[108:109], v[68:69]
    v_mov_b64 v[110:111], v[68:69]
    v_mov_b64 v[116:117], v[68:69]
    v_mov_b64 v[118:119], v[68:69]
    v_mov_b64 v[124:125], v[68:69]
    v_mov_b64 v[126:127], v[68:69]
    v_mov_b64 v[132:133], v[68:69]
    v_mov_b64 v[134:135], v[68:69]
    v_mov_b64 v[140:141], v[68:69]
    v_mov_b64 v[142:143], v[68:69]
    v_mov_b64 v[148:149], v[68:69]
    v_mov_b64 v[150:151], v[68:69]
    v_mov_b64 v[156:157], v[68:69]
    v_mov_b64 v[158:159], v[68:69]
    v_mov_b64 v[164:165], v[68:69]
    v_mov_b64 v[166:167], v[68:69]
    v_mov_b64 v[172:173], v[68:69]
    v_mov_b64 v[174:175], v[68:69]
    v_mov_b64 v[180:181], v[68:69]
    v_mov_b64 v[182:183], v[68:69]
    v_mov_b64 v[188:189], v[68:69]
    v_mov_b64 v[190:191], v[68:69]
    s_waitcnt vmcnt(0) lgkmcnt(0)
    s_barrier
    ds_read_b64_tr_b16 v[192:193], v184 offset:0
    ds_read_b64_tr_b16 v[194:195], v184 offset:512
    ds_read_b128 v[196:199], v168 offset:0
    ds_read_b64_tr_b16 v[200:201], v184 offset:2048
    ds_read_b64_tr_b16 v[202:203], v184 offset:2560
    ds_read_b128 v[204:207], v169 offset:0
    ds_read_b64_tr_b16 v[208:209], v184 offset:4096
    ds_read_b64_tr_b16 v[210:211], v184 offset:4608
    ds_read_b128 v[212:215], v170 offset:0
    s_waitcnt lgkmcnt(6)
    v_mfma_f32_32x32x16_bf16 v[224:239], v[192:195], v[196:199], 0
    ds_read_b64_tr_b16 v[192:193], v184 offset:6144
    ds_read_b64_tr_b16 v[194:195], v184 offset:6656
    ds_read_b128 v[196:199], v171 offset:0
    s_waitcnt lgkmcnt(6)
    v_mfma_f32_32x32x16_bf16 v[224:239], v[200:203], v[204:207], v[224:239]
    ds_read_b64_tr_b16 v[200:201], v184 offset:8192
    ds_read_b64_tr_b16 v[202:203], v184 offset:8704
    ds_read_b128 v[204:207], v176 offset:0
    s_waitcnt lgkmcnt(6)
    v_mfma_f32_32x32x16_bf16 v[224:239], v[208:211], v[212:215], v[224:239]
    ds_read_b64_tr_b16 v[208:209], v184 offset:10240
    ds_read_b64_tr_b16 v[210:211], v184 offset:10752
    ds_read_b128 v[212:215], v177 offset:0
    s_waitcnt lgkmcnt(6)
    v_mfma_f32_32x32x16_bf16 v[224:239], v[192:195], v[196:199], v[224:239]
    ds_read_b64_tr_b16 v[192:193], v184 offset:12288
    ds_read_b64_tr_b16 v[194:195], v184 offset:12800
    ds_read_b128 v[196:199], v178 offset:0
    s_waitcnt lgkmcnt(6)
    v_mfma_f32_32x32x16_bf16 v[224:239], v[200:203], v[204:207], v[224:239]
    ds_read_b64_tr_b16 v[200:201], v184 offset:14336
    ds_read_b64_tr_b16 v[202:203], v184 offset:14848
    ds_read_b128 v[204:207], v179 offset:0
    s_waitcnt lgkmcnt(6)
    v_mfma_f32_32x32x16_bf16 v[224:239], v[208:211], v[212:215], v[224:239]
    s_waitcnt lgkmcnt(3)
    v_mfma_f32_32x32x16_bf16 v[224:239], v[192:195], v[196:199], v[224:239]
    s_waitcnt lgkmcnt(0)
    v_mfma_f32_32x32x16_bf16 v[224:239], v[200:203], v[204:207], v[224:239]
    s_barrier
    v_mov_b32 v253, 162816
    ds_read_b32 v253, v253
    ds_read_b64_tr_b16 v[208:209], v184 offset:16384
    ds_read_b64_tr_b16 v[210:211], v184 offset:16896
    ds_read_b128 v[212:215], v168 offset:16384
    ds_read_b64_tr_b16 v[192:193], v184 offset:18432
    ds_read_b64_tr_b16 v[194:195], v184 offset:18944
    ds_read_b128 v[196:199], v169 offset:16384
    ds_read_b64_tr_b16 v[200:201], v184 offset:20480
    ds_read_b64_tr_b16 v[202:203], v184 offset:20992
    ds_read_b128 v[204:207], v170 offset:16384
    s_waitcnt lgkmcnt(6)
    v_mfma_f32_32x32x16_bf16 v[224:239], v[208:211], v[212:215], v[224:239]
    ds_read_b64_tr_b16 v[208:209], v184 offset:22528
    ds_read_b64_tr_b16 v[210:211], v184 offset:23040
    ds_read_b128 v[212:215], v171 offset:16384
    s_waitcnt lgkmcnt(6)
    v_mfma_f32_32x32x16_bf16 v[224:239], v[192:195], v[196:199], v[224:239]
    ds_read_b64_tr_b16 v[192:193], v184 offset:24576
    ds_read_b64_tr_b16 v[194:195], v184 offset:25088
    ds_read_b128 v[196:199], v176 offset:16384
    s_waitcnt lgkmcnt(6)
    v_mfma_f32_32x32x16_bf16 v[224:239], v[200:203], v[204:207], v[224:239]
    ds_read_b64_tr_b16 v[200:201], v184 offset:26624
    ds_read_b64_tr_b16 v[202:203], v184 offset:27136
    ds_read_b128 v[204:207], v177 offset:16384
    s_waitcnt lgkmcnt(6)
    v_mfma_f32_32x32x16_bf16 v[224:239], v[208:211], v[212:215], v[224:239]
    ds_read_b64_tr_b16 v[208:209], v184 offset:28672
    ds_read_b64_tr_b16 v[210:211], v184 offset:29184
    ds_read_b128 v[212:215], v178 offset:16384
    s_waitcnt lgkmcnt(6)
    v_mfma_f32_32x32x16_bf16 v[224:239], v[192:195], v[196:199], v[224:239]
    ds_read_b64_tr_b16 v[192:193], v184 offset:30720
    ds_read_b64_tr_b16 v[194:195], v184 offset:31232
    ds_read_b128 v[196:199], v179 offset:16384
    s_waitcnt lgkmcnt(6)
    v_mfma_f32_32x32x16_bf16 v[224:239], v[200:203], v[204:207], v[224:239]
    s_waitcnt lgkmcnt(3)
    v_mfma_f32_32x32x16_bf16 v[224:239], v[208:211], v[212:215], v[224:239]
    s_waitcnt lgkmcnt(0)
    v_mfma_f32_32x32x16_bf16 v[224:239], v[192:195], v[196:199], v[224:239]
    v_readfirstlane_b32 s53, v253
    s_barrier
    buffer_load_dwordx2 v[248:249], v247, s[44:47], s60 offen sc1
    ds_read_b64_tr_b16 v[200:201], v184 offset:32768
    ds_read_b64_tr_b16 v[202:203], v184 offset:33280
    ds_read_b128 v[204:207], v168 offset:32768
    ds_read_b64_tr_b16 v[208:209], v184 offset:34816
    ds_read_b64_tr_b16 v[210:211], v184 offset:35328
    ds_read_b128 v[212:215], v169 offset:32768
    ds_read_b64_tr_b16 v[192:193], v184 offset:36864
    ds_read_b64_tr_b16 v[194:195], v184 offset:37376
    ds_read_b128 v[196:199], v170 offset:32768
    s_waitcnt lgkmcnt(6)
    v_mfma_f32_32x32x16_bf16 v[224:239], v[200:203], v[204:207], v[224:239]
    ds_read_b64_tr_b16 v[200:201], v184 offset:38912
    ds_read_b64_tr_b16 v[202:203], v184 offset:39424
    ds_read_b128 v[204:207], v171 offset:32768
    s_waitcnt lgkmcnt(6)
    v_mfma_f32_32x32x16_bf16 v[224:239], v[208:211], v[212:215], v[224:239]
    ds_read_b64_tr_b16 v[208:209], v184 offset:40960
    ds_read_b64_tr_b16 v[210:211], v184 offset:41472
    ds_read_b128 v[212:215], v176 offset:32768
    s_waitcnt lgkmcnt(6)
    v_mfma_f32_32x32x16_bf16 v[224:239], v[192:195], v[196:199], v[224:239]
    ds_read_b64_tr_b16 v[192:193], v184 offset:43008
    ds_read_b64_tr_b16 v[194:195], v184 offset:43520
    ds_read_b128 v[196:199], v177 offset:32768
    s_waitcnt lgkmcnt(6)
    v_mfma_f32_32x32x16_bf16 v[224:239], v[200:203], v[204:207], v[224:239]
    ds_read_b64_tr_b16 v[200:201], v184 offset:45056
    ds_read_b64_tr_b16 v[202:203], v184 offset:45568
    ds_read_b128 v[204:207], v178 offset:32768
    s_waitcnt lgkmcnt(6)
    v_mfma_f32_32x32x16_bf16 v[224:239], v[208:211], v[212:215], v[224:239]
    ds_read_b64_tr_b16 v[208:209], v184 offset:47104
    ds_read_b64_tr_b16 v[210:211], v184 offset:47616
    ds_read_b128 v[212:215], v179 offset:32768
    s_waitcnt lgkmcnt(6)
    v_mfma_f32_32x32x16_bf16 v[224:239], v[192:195], v[196:199], v[224:239]
    s_waitcnt lgkmcnt(3)
    v_mfma_f32_32x32x16_bf16 v[224:239], v[200:203], v[204:207], v[224:239]
    s_waitcnt lgkmcnt(0)
    v_mfma_f32_32x32x16_bf16 v[224:239], v[208:211], v[212:215], v[224:239]
    s_barrier
    ds_read_b64_tr_b16 v[192:193], v184 offset:49152
    ds_read_b64_tr_b16 v[194:195], v184 offset:49664
    ds_read_b128 v[196:199], v168 offset:49152
    ds_read_b64_tr_b16 v[200:201], v184 offset:51200
    ds_read_b64_tr_b16 v[202:203], v184 offset:51712
    ds_read_b128 v[204:207], v169 offset:49152
    ds_read_b64_tr_b16 v[208:209], v184 offset:53248
    ds_read_b64_tr_b16 v[210:211], v184 offset:53760
    ds_read_b128 v[212:215], v170 offset:49152
    s_waitcnt lgkmcnt(6)
    v_mfma_f32_32x32x16_bf16 v[224:239], v[192:195], v[196:199], v[224:239]
    ds_read_b64_tr_b16 v[192:193], v184 offset:55296
    ds_read_b64_tr_b16 v[194:195], v184 offset:55808
    ds_read_b128 v[196:199], v171 offset:49152
    s_waitcnt lgkmcnt(6)
    v_mfma_f32_32x32x16_bf16 v[224:239], v[200:203], v[204:207], v[224:239]
    ds_read_b64_tr_b16 v[200:201], v184 offset:57344
    ds_read_b64_tr_b16 v[202:203], v184 offset:57856
    ds_read_b128 v[204:207], v176 offset:49152
    s_waitcnt lgkmcnt(6)
    v_mfma_f32_32x32x16_bf16 v[224:239], v[208:211], v[212:215], v[224:239]
    s_waitcnt vmcnt(0)
    v_cmp_ne_u32 vcc, s53, v248
    s_nop 3
    s_cmp_eq_u64 vcc, 0
    s_cselect_b32 s14, 16777216, 0
    buffer_load_dwordx2 v[248:249], v247, s[12:15], s61 offen sc1
    buffer_load_dwordx4 v[0:3], v250, s[12:15], s8 offen offset:0 sc1
    ds_read_b64_tr_b16 v[208:209], v184 offset:59392
    ds_read_b64_tr_b16 v[210:211], v184 offset:59904
    ds_read_b128 v[212:215], v177 offset:49152
    s_waitcnt lgkmcnt(6)
    v_mfma_f32_32x32x16_bf16 v[224:239], v[192:195], v[196:199], v[224:239]
    buffer_load_dwordx4 v[64:67], v252, s[12:15], s8 offen offset:0 sc1
    ds_read_b64_tr_b16 v[192:193], v184 offset:61440
    ds_read_b64_tr_b16 v[194:195], v184 offset:61952
    ds_read_b128 v[196:199], v178 offset:49152
    s_waitcnt lgkmcnt(6)
    v_mfma_f32_32x32x16_bf16 v[224:239], v[200:203], v[204:207], v[224:239]
    buffer_load_dwordx4 v[4:7], v250, s[12:15], s8 offen offset:1024 sc1
    ds_read_b64_tr_b16 v[200:201], v184 offset:63488
    ds_read_b64_tr_b16 v[202:203], v184 offset:64000
    ds_read_b128 v[204:207], v179 offset:49152
    s_waitcnt lgkmcnt(6)
    v_mfma_f32_32x32x16_bf16 v[224:239], v[208:211], v[212:215], v[224:239]
    buffer_load_dwordx4 v[72:75], v252, s[12:15], s8 offen offset:1024 sc1
    s_waitcnt lgkmcnt(3)
    v_mfma_f32_32x32x16_bf16 v[224:239], v[192:195], v[196:199], v[224:239]
    s_waitcnt lgkmcnt(0)
    s_barrier
    v_mfma_f32_32x32x16_bf16 v[224:239], v[200:203], v[204:207], v[224:239]
    s_setprio 2
    v_mov_b32 v245, s53
    s_mov_b32 s63, 0
    buffer_load_dwordx4 v[8:11], v250, s[12:15], s8 offen offset:2048 sc1
    buffer_load_dwordx4 v[80:83], v252, s[12:15], s8 offen offset:2048 sc1
    buffer_load_dwordx4 v[12:15], v250, s[12:15], s8 offen offset:3072 sc1
    buffer_load_dwordx4 v[88:91], v252, s[12:15], s8 offen offset:3072 sc1
    buffer_load_dwordx4 v[16:19], v250, s[12:15], s9 offen offset:0 sc1
    buffer_load_dwordx4 v[96:99], v252, s[12:15], s9 offen offset:0 sc1
    s_nop 2
    v_cvt_pk_bf16_f32 v192, v224, v225
    v_cvt_pk_bf16_f32 v193, v226, v227
    v_cvt_pk_bf16_f32 v194, v228, v229
    v_cvt_pk_bf16_f32 v195, v230, v231
    v_cvt_pk_bf16_f32 v196, v232, v233
    v_cvt_pk_bf16_f32 v197, v234, v235
    v_cvt_pk_bf16_f32 v198, v236, v237
    v_cvt_pk_bf16_f32 v199, v238, v239
    ds_write_b128 v220, v[192:195]
    ds_write_b128 v220, v[196:199] offset:1024
    s_cmp_lg_u32 s50, 0
    s_cbranch_scc1 L_q0s
    ds_write_b32 v251, v245 offset:96
L_q0s:
    ds_read_b32 v210, v251 offset:96
    ds_read_b128 v[240:243], v246
    v_dot2_f32_bf16 v208, v192, v192, 0
    v_dot2_f32_bf16 v209, v196, v196, 0
    v_dot2_f32_bf16 v208, v193, v193, v208
    v_dot2_f32_bf16 v209, v197, v197, v209
    v_dot2_f32_bf16 v208, v194, v194, v208
    v_dot2_f32_bf16 v209, v198, v198, v209
    v_dot2_f32_bf16 v208, v195, v195, v208
    v_dot2_f32_bf16 v209, v199, v199, v209
    s_branch L_q0c
L_q0w:
    ds_read_b32 v210, v251 offset:96
    ds_read_b128 v[240:243], v246
    s_add_u32 s63, s63, 1
    s_cmp_gt_u32 s63, 1000000
    s_cbranch_scc1 L_q0x
L_q0c:
    s_waitcnt lgkmcnt(0)
    v_cmp_ne_u32 vcc, s53, v210
    s_cbranch_vccnz L_q0w
L_q0x:
    s_waitcnt vmcnt(10)
    v_cmp_ne_u32 vcc, s53, v248
    s_cbranch_vccnz L_kvlate
L_kvgo:
    v_permlane32_swap_b32 v208, v209
    v_max_u32_dpp v249, v249, v249 row_ror:8 row_mask:0xf bank_mask:0xf
    v_add_f32 v254, v208, v209
    v_mov_b32 v253, 1
    v_max_u32_dpp v249, v249, v249 row_ror:4 row_mask:0xf bank_mask:0xf
    v_max_u32_dpp v254, v254, v254 row_ror:8 row_mask:0xf bank_mask:0xf
    s_mov_b32 s64, 0x00010001
    v_max_u32_dpp v249, v249, v249 row_ror:2 row_mask:0xf bank_mask:0xf
    v_max_u32_dpp v254, v254, v254 row_ror:4 row_mask:0xf bank_mask:0xf
    s_mov_b32 s65, 0x00010001
    v_max_u32_dpp v249, v249, v249 row_ror:1 row_mask:0xf bank_mask:0xf
    v_max_u32_dpp v254, v254, v254 row_ror:2 row_mask:0xf bank_mask:0xf
    v_add_u32 v246, 1024, v246
    s_mov_b32 s62, 6
    v_max_u32_dpp v254, v254, v254 row_ror:1 row_mask:0xf bank_mask:0xf
    s_mov_b64 exec, s[64:65]
    ds_max_u32 v251, v254
    ds_max_u32 v251, v249 offset:4
    ds_add_u32 v251, v253 offset:8
    s_mov_b64 exec, -1
    s_mov_b32 s64, 36
    s_mov_b32 s65, 0
L_qk0:
    s_waitcnt vmcnt(9)
    v_mfma_f32_32x32x16_bf16 v[192:207], v[0:3], v[240:243], 0
    v_max_u32 v254, v0, v2
    s_nop 1
    buffer_load_dwordx4 v[20:23], v250, s[12:15], s9 offen offset:1024 sc1
    buffer_load_dwordx4 v[104:107], v252, s[12:15], s9 offen offset:1024 sc1
    s_waitcnt vmcnt(9)
    v_max3_u32 v254, v254, v64, v66
    v_max3_u32 v254, v254, v4, v6
    v_permlane16_swap_b32 v64, v68
    v_permlane16_swap_b32 v65, v69
    v_permlane16_swap_b32 v66, v70
    v_permlane16_swap_b32 v67, v71
    v_exp_f32 v192, v192
    v_exp_f32 v193, v193
    v_exp_f32 v194, v194
    v_cvt_pk_bf16_f32 v192, v192, v193
    v_exp_f32 v195, v195
    v_exp_f32 v196, v196
    v_exp_f32 v197, v197
    v_mfma_f32_32x32x16_bf16 v[208:223], v[4:7], v[240:243], 0
    v_exp_f32 v198, v198
    v_exp_f32 v199, v199
    v_exp_f32 v200, v200
    v_cvt_pk_bf16_f32 v193, v194, v195
    v_exp_f32 v201, v201
    v_exp_f32 v202, v202
    v_exp_f32 v203, v203
    v_cvt_pk_bf16_f32 v194, v196, v197
    v_exp_f32 v204, v204
    v_exp_f32 v205, v205
    v_cvt_pk_bf16_f32 v195, v198, v199
    v_cvt_pk_bf16_f32 v196, v200, v201
    v_exp_f32 v206, v206
    v_mfma_f32_32x32x16_bf16 v[224:239], v[64:67], v[192:195], 0
    v_cvt_pk_bf16_f32 v197, v202, v203
    v_cvt_pk_bf16_f32 v198, v204, v205
    v_exp_f32 v207, v207
    buffer_load_dwordx4 v[24:27], v250, s[12:15], s9 offen offset:2048 sc1
    buffer_load_dwordx4 v[112:115], v252, s[12:15], s9 offen offset:2048 sc1
    s_waitcnt vmcnt(9)
    v_max3_u32 v254, v254, v72, v74
    v_max3_u32 v254, v254, v8, v10
    v_permlane16_swap_b32 v72, v76
    v_permlane16_swap_b32 v73, v77
    v_permlane16_swap_b32 v74, v78
    v_permlane16_swap_b32 v75, v79
    v_exp_f32 v208, v208
    v_cvt_pk_bf16_f32 v199, v206, v207
    v_exp_f32 v209, v209
    v_exp_f32 v210, v210
    v_cvt_pk_bf16_f32 v208, v208, v209
    v_mfma_f32_32x32x16_bf16 v[224:239], v[68:71], v[196:199], v[224:239]
    v_exp_f32 v211, v211
    v_exp_f32 v212, v212
    v_exp_f32 v213, v213
    v_mfma_f32_32x32x16_bf16 v[192:207], v[8:11], v[240:243], 0
    v_exp_f32 v214, v214
    v_exp_f32 v215, v215
    v_exp_f32 v216, v216
    v_cvt_pk_bf16_f32 v209, v210, v211
    v_exp_f32 v217, v217
    v_exp_f32 v218, v218
    v_exp_f32 v219, v219
    v_cvt_pk_bf16_f32 v210, v212, v213
    v_exp_f32 v220, v220
    v_exp_f32 v221, v221
    v_cvt_pk_bf16_f32 v211, v214, v215
    v_cvt_pk_bf16_f32 v212, v216, v217
    v_exp_f32 v222, v222
    v_mfma_f32_32x32x16_bf16 v[224:239], v[72:75], v[208:211], v[224:239]
    v_cvt_pk_bf16_f32 v213, v218, v219
    v_cvt_pk_bf16_f32 v214, v220, v221
    v_exp_f32 v223, v223
    buffer_load_dwordx4 v[28:31], v250, s[12:15], s9 offen offset:3072 sc1
    buffer_load_dwordx4 v[120:123], v252, s[12:15], s9 offen offset:3072 sc1
    s_waitcnt vmcnt(9)
    v_max3_u32 v254, v254, v80, v82
    v_max3_u32 v254, v254, v12, v14
    v_permlane16_swap_b32 v80, v84
    v_permlane16_swap_b32 v81, v85
    v_permlane16_swap_b32 v82, v86
    v_permlane16_swap_b32 v83, v87
    v_exp_f32 v192, v192
    v_cvt_pk_bf16_f32 v215, v222, v223
    v_exp_f32 v193, v193
    v_exp_f32 v194, v194
    v_cvt_pk_bf16_f32 v192, v192, v193
    v_mfma_f32_32x32x16_bf16 v[224:239], v[76:79], v[212:215], v[224:239]
    v_exp_f32 v195, v195
    v_exp_f32 v196, v196
    v_exp_f32 v197, v197
    v_mfma_f32_32x32x16_bf16 v[208:223], v[12:15], v[240:243], 0
    v_exp_f32 v198, v198
    v_exp_f32 v199, v199
    v_exp_f32 v200, v200
    v_cvt_pk_bf16_f32 v193, v194, v195
    v_exp_f32 v201, v201
    v_exp_f32 v202, v202
    v_exp_f32 v203, v203
    v_cvt_pk_bf16_f32 v194, v196, v197
    v_exp_f32 v204, v204
    v_exp_f32 v205, v205
    v_cvt_pk_bf16_f32 v195, v198, v199
    v_cvt_pk_bf16_f32 v196, v200, v201
    v_exp_f32 v206, v206
    v_mfma_f32_32x32x16_bf16 v[224:239], v[80:83], v[192:195], v[224:239]
    v_cvt_pk_bf16_f32 v197, v202, v203
    v_cvt_pk_bf16_f32 v198, v204, v205
    v_exp_f32 v207, v207
    buffer_load_dwordx4 v[32:35], v250, s[12:15], s10 offen offset:0 sc1
    buffer_load_dwordx4 v[128:131], v252, s[12:15], s10 offen offset:0 sc1
    s_waitcnt vmcnt(9)
    v_max3_u32 v254, v254, v88, v90
    v_max3_u32 v254, v254, v16, v18
    v_permlane16_swap_b32 v88, v92
    v_permlane16_swap_b32 v89, v93
    v_permlane16_swap_b32 v90, v94
    v_permlane16_swap_b32 v91, v95
    v_exp_f32 v208, v208
    v_cvt_pk_bf16_f32 v199, v206, v207
    v_exp_f32 v209, v209
    v_exp_f32 v210, v210
    v_cvt_pk_bf16_f32 v208, v208, v209
    v_mfma_f32_32x32x16_bf16 v[224:239], v[84:87], v[196:199], v[224:239]
    v_exp_f32 v211, v211
    v_exp_f32 v212, v212
    v_exp_f32 v213, v213
    v_mfma_f32_32x32x16_bf16 v[192:207], v[16:19], v[240:243], 0
    v_exp_f32 v214, v214
    v_exp_f32 v215, v215
    v_exp_f32 v216, v216
    v_cvt_pk_bf16_f32 v209, v210, v211
    v_exp_f32 v217, v217
    v_exp_f32 v218, v218
    v_exp_f32 v219, v219
    v_cvt_pk_bf16_f32 v210, v212, v213
    v_exp_f32 v220, v220
    v_exp_f32 v221, v221
    v_cvt_pk_bf16_f32 v211, v214, v215
    v_cvt_pk_bf16_f32 v212, v216, v217
    v_exp_f32 v222, v222
    v_mfma_f32_32x32x16_bf16 v[224:239], v[88:91], v[208:211], v[224:239]
    v_cvt_pk_bf16_f32 v213, v218, v219
    v_cvt_pk_bf16_f32 v214, v220, v221
    v_exp_f32 v223, v223
    buffer_load_dwordx4 v[36:39], v250, s[12:15], s10 offen offset:1024 sc1
    buffer_load_dwordx4 v[136:139], v252, s[12:15], s10 offen offset:1024 sc1
    s_waitcnt vmcnt(9)
    v_max3_u32 v254, v254, v96, v98
    v_max3_u32 v254, v254, v20, v22
    v_permlane16_swap_b32 v96, v100
    v_permlane16_swap_b32 v97, v101
    v_permlane16_swap_b32 v98, v102
    v_permlane16_swap_b32 v99, v103
    v_exp_f32 v192, v192
    v_cvt_pk_bf16_f32 v215, v222, v223
    v_exp_f32 v193, v193
    v_exp_f32 v194, v194
    v_cvt_pk_bf16_f32 v192, v192, v193
    v_mfma_f32_32x32x16_bf16 v[224:239], v[92:95], v[212:215], v[224:239]
    v_exp_f32 v195, v195
    v_exp_f32 v196, v196
    v_exp_f32 v197, v197
    v_mfma_f32_32x32x16_bf16 v[208:223], v[20:23], v[240:243], 0
    v_exp_f32 v198, v198
    v_exp_f32 v199, v199
    v_exp_f32 v200, v200
    v_cvt_pk_bf16_f32 v193, v194, v195
    v_exp_f32 v201, v201
    v_exp_f32 v202, v202
    v_exp_f32 v203, v203
    v_cvt_pk_bf16_f32 v194, v196, v197
    v_exp_f32 v204, v204
    v_exp_f32 v205, v205
    v_cvt_pk_bf16_f32 v195, v198, v199
    v_cvt_pk_bf16_f32 v196, v200, v201
    v_exp_f32 v206, v206
    v_mfma_f32_32x32x16_bf16 v[224:239], v[96:99], v[192:195], v[224:239]
    v_cvt_pk_bf16_f32 v197, v202, v203
    v_cvt_pk_bf16_f32 v198, v204, v205
    v_exp_f32 v207, v207
    buffer_load_dwordx4 v[40:43], v250, s[12:15], s10 offen offset:2048 sc1
    buffer_load_dwordx4 v[144:147], v252, s[12:15], s10 offen offset:2048 sc1
    s_waitcnt vmcnt(9)
    v_max3_u32 v254, v254, v104, v106
    v_max3_u32 v254, v254, v24, v26
    v_permlane16_swap_b32 v104, v108
    v_permlane16_swap_b32 v105, v109
    v_permlane16_swap_b32 v106, v110
    v_permlane16_swap_b32 v107, v111
    v_exp_f32 v208, v208
    v_cvt_pk_bf16_f32 v199, v206, v207
    v_exp_f32 v209, v209
    v_exp_f32 v210, v210
    v_cvt_pk_bf16_f32 v208, v208, v209
    v_mfma_f32_32x32x16_bf16 v[224:239], v[100:103], v[196:199], v[224:239]
    v_exp_f32 v211, v211
    v_exp_f32 v212, v212
    v_exp_f32 v213, v213
    v_mfma_f32_32x32x16_bf16 v[192:207], v[24:27], v[240:243], 0
    v_exp_f32 v214, v214
    v_exp_f32 v215, v215
    v_exp_f32 v216, v216
    v_cvt_pk_bf16_f32 v209, v210, v211
    v_exp_f32 v217, v217
    v_exp_f32 v218, v218
    v_exp_f32 v219, v219
    v_cvt_pk_bf16_f32 v210, v212, v213
    v_exp_f32 v220, v220
    v_exp_f32 v221, v221
    v_cvt_pk_bf16_f32 v211, v214, v215
    v_cvt_pk_bf16_f32 v212, v216, v217
    v_exp_f32 v222, v222
    v_mfma_f32_32x32x16_bf16 v[224:239], v[104:107], v[208:211], v[224:239]
    v_cvt_pk_bf16_f32 v213, v218, v219
    v_cvt_pk_bf16_f32 v214, v220, v221
    v_exp_f32 v223, v223
    buffer_load_dwordx4 v[44:47], v250, s[12:15], s10 offen offset:3072 sc1
    buffer_load_dwordx4 v[152:155], v252, s[12:15], s10 offen offset:3072 sc1
    s_waitcnt vmcnt(9)
    v_max3_u32 v254, v254, v112, v114
    v_max3_u32 v254, v254, v28, v30
    v_permlane16_swap_b32 v112, v116
    v_permlane16_swap_b32 v113, v117
    v_permlane16_swap_b32 v114, v118
    v_permlane16_swap_b32 v115, v119
    v_exp_f32 v192, v192
    v_cvt_pk_bf16_f32 v215, v222, v223
    v_exp_f32 v193, v193
    v_exp_f32 v194, v194
    v_cvt_pk_bf16_f32 v192, v192, v193
    v_mfma_f32_32x32x16_bf16 v[224:239], v[108:111], v[212:215], v[224:239]
    v_exp_f32 v195, v195
    v_exp_f32 v196, v196
    v_exp_f32 v197, v197
    v_mfma_f32_32x32x16_bf16 v[208:223], v[28:31], v[240:243], 0
    v_exp_f32 v198, v198
    v_exp_f32 v199, v199
    v_exp_f32 v200, v200
    v_cvt_pk_bf16_f32 v193, v194, v195
    v_exp_f32 v201, v201
    v_exp_f32 v202, v202
    v_exp_f32 v203, v203
    v_cvt_pk_bf16_f32 v194, v196, v197
    v_exp_f32 v204, v204
    v_exp_f32 v205, v205
    v_cvt_pk_bf16_f32 v195, v198, v199
    v_cvt_pk_bf16_f32 v196, v200, v201
    v_exp_f32 v206, v206
    v_mfma_f32_32x32x16_bf16 v[224:239], v[112:115], v[192:195], v[224:239]
    v_cvt_pk_bf16_f32 v197, v202, v203
    v_cvt_pk_bf16_f32 v198, v204, v205
    v_exp_f32 v207, v207
    buffer_load_dwordx4 v[48:51], v250, s[12:15], s11 offen offset:0 sc1
    buffer_load_dwordx4 v[160:163], v252, s[12:15], s11 offen offset:0 sc1
    s_waitcnt vmcnt(9)
    v_max3_u32 v254, v254, v120, v122
    v_max3_u32 v254, v254, v32, v34
    v_permlane16_swap_b32 v120, v124
    v_permlane16_swap_b32 v121, v125
    v_permlane16_swap_b32 v122, v126
    v_permlane16_swap_b32 v123, v127
    v_exp_f32 v208, v208
    v_cvt_pk_bf16_f32 v199, v206, v207
    v_exp_f32 v209, v209
    v_exp_f32 v210, v210
    v_cvt_pk_bf16_f32 v208, v208, v209
    v_mfma_f32_32x32x16_bf16 v[224:239], v[116:119], v[196:199], v[224:239]
    v_exp_f32 v211, v211
    v_exp_f32 v212, v212
    v_exp_f32 v213, v213
    v_mfma_f32_32x32x16_bf16 v[192:207], v[32:35], v[240:243], 0
    v_exp_f32 v214, v214
    v_exp_f32 v215, v215
    v_exp_f32 v216, v216
    v_cvt_pk_bf16_f32 v209, v210, v211
    v_exp_f32 v217, v217
    v_exp_f32 v218, v218
    v_exp_f32 v219, v219
    v_cvt_pk_bf16_f32 v210, v212, v213
    v_exp_f32 v220, v220
    v_exp_f32 v221, v221
    v_cvt_pk_bf16_f32 v211, v214, v215
    v_cvt_pk_bf16_f32 v212, v216, v217
    v_exp_f32 v222, v222
    v_mfma_f32_32x32x16_bf16 v[224:239], v[120:123], v[208:211], v[224:239]
    v_cvt_pk_bf16_f32 v213, v218, v219
    v_cvt_pk_bf16_f32 v214, v220, v221
    v_exp_f32 v223, v223
    buffer_load_dwordx4 v[52:55], v250, s[12:15], s11 offen offset:1024 sc1
    buffer_load_dwordx4 v[168:171], v252, s[12:15], s11 offen offset:1024 sc1
    s_waitcnt vmcnt(9)
    v_max3_u32 v254, v254, v128, v130
    v_max3_u32 v254, v254, v36, v38
    v_permlane16_swap_b32 v128, v132
    v_permlane16_swap_b32 v129, v133
    v_permlane16_swap_b32 v130, v134
    v_permlane16_swap_b32 v131, v135
    v_exp_f32 v192, v192
    v_cvt_pk_bf16_f32 v215, v222, v223
    v_exp_f32 v193, v193
    v_exp_f32 v194, v194
    v_cvt_pk_bf16_f32 v192, v192, v193
    v_mfma_f32_32x32x16_bf16 v[224:239], v[124:127], v[212:215], v[224:239]
    v_exp_f32 v195, v195
    v_exp_f32 v196, v196
    v_exp_f32 v197, v197
    v_mfma_f32_32x32x16_bf16 v[208:223], v[36:39], v[240:243], 0
    v_exp_f32 v198, v198
    v_exp_f32 v199, v199
    v_exp_f32 v200, v200
    v_cvt_pk_bf16_f32 v193, v194, v195
    v_exp_f32 v201, v201
    v_exp_f32 v202, v202
    v_exp_f32 v203, v203
    v_cvt_pk_bf16_f32 v194, v196, v197
    v_exp_f32 v204, v204
    v_exp_f32 v205, v205
    v_cvt_pk_bf16_f32 v195, v198, v199
    v_cvt_pk_bf16_f32 v196, v200, v201
    v_exp_f32 v206, v206
    v_mfma_f32_32x32x16_bf16 v[224:239], v[128:131], v[192:195], v[224:239]
    v_cvt_pk_bf16_f32 v197, v202, v203
    v_cvt_pk_bf16_f32 v198, v204, v205
    v_exp_f32 v207, v207
    buffer_load_dwordx4 v[56:59], v250, s[12:15], s11 offen offset:2048 sc1
    buffer_load_dwordx4 v[176:179], v252, s[12:15], s11 offen offset:2048 sc1
    s_waitcnt vmcnt(9)
    v_max3_u32 v254, v254, v136, v138
    v_max3_u32 v254, v254, v40, v42
    v_permlane16_swap_b32 v136, v140
    v_permlane16_swap_b32 v137, v141
    v_permlane16_swap_b32 v138, v142
    v_permlane16_swap_b32 v139, v143
    v_exp_f32 v208, v208
    v_cvt_pk_bf16_f32 v199, v206, v207
    v_exp_f32 v209, v209
    v_exp_f32 v210, v210
    v_cvt_pk_bf16_f32 v208, v208, v209
    v_mfma_f32_32x32x16_bf16 v[224:239], v[132:135], v[196:199], v[224:239]
    v_exp_f32 v211, v211
    v_exp_f32 v212, v212
    v_exp_f32 v213, v213
    v_mfma_f32_32x32x16_bf16 v[192:207], v[40:43], v[240:243], 0
    v_exp_f32 v214, v214
    v_exp_f32 v215, v215
    v_exp_f32 v216, v216
    v_cvt_pk_bf16_f32 v209, v210, v211
    v_exp_f32 v217, v217
    v_exp_f32 v218, v218
    v_exp_f32 v219, v219
    v_cvt_pk_bf16_f32 v210, v212, v213
    v_exp_f32 v220, v220
    v_exp_f32 v221, v221
    v_cvt_pk_bf16_f32 v211, v214, v215
    v_cvt_pk_bf16_f32 v212, v216, v217
    v_exp_f32 v222, v222
    v_mfma_f32_32x32x16_bf16 v[224:239], v[136:139], v[208:211], v[224:239]
    v_cvt_pk_bf16_f32 v213, v218, v219
    v_cvt_pk_bf16_f32 v214, v220, v221
    v_exp_f32 v223, v223
    buffer_load_dwordx4 v[60:63], v250, s[12:15], s11 offen offset:3072 sc1
    buffer_load_dwordx4 v[184:187], v252, s[12:15], s11 offen offset:3072 sc1
    s_waitcnt vmcnt(9)
    v_max3_u32 v254, v254, v144, v146
    v_max3_u32 v254, v254, v44, v46
    v_permlane16_swap_b32 v144, v148
    v_permlane16_swap_b32 v145, v149
    v_permlane16_swap_b32 v146, v150
    v_permlane16_swap_b32 v147, v151
    v_exp_f32 v192, v192
    v_cvt_pk_bf16_f32 v215, v222, v223
    v_exp_f32 v193, v193
    v_exp_f32 v194, v194
    v_cvt_pk_bf16_f32 v192, v192, v193
    v_mfma_f32_32x32x16_bf16 v[224:239], v[140:143], v[212:215], v[224:239]
    v_exp_f32 v195, v195
    v_exp_f32 v196, v196
    v_exp_f32 v197, v197
    v_mfma_f32_32x32x16_bf16 v[208:223], v[44:47], v[240:243], 0
    v_exp_f32 v198, v198
    v_exp_f32 v199, v199
    v_exp_f32 v200, v200
    v_cvt_pk_bf16_f32 v193, v194, v195
    v_exp_f32 v201, v201
    v_exp_f32 v202, v202
    v_exp_f32 v203, v203
    v_cvt_pk_bf16_f32 v194, v196, v197
    v_exp_f32 v204, v204
    v_exp_f32 v205, v205
    v_cvt_pk_bf16_f32 v195, v198, v199
    v_cvt_pk_bf16_f32 v196, v200, v201
    v_exp_f32 v206, v206
    v_mfma_f32_32x32x16_bf16 v[224:239], v[144:147], v[192:195], v[224:239]
    v_cvt_pk_bf16_f32 v197, v202, v203
    v_cvt_pk_bf16_f32 v198, v204, v205
    v_exp_f32 v207, v207
    ds_write_b32 v251, v245 offset:100
    s_waitcnt vmcnt(7)
    v_max3_u32 v254, v254, v152, v154
    v_max3_u32 v254, v254, v48, v50
    v_permlane16_swap_b32 v152, v156
    v_permlane16_swap_b32 v153, v157
    v_permlane16_swap_b32 v154, v158
    v_permlane16_swap_b32 v155, v159
    v_exp_f32 v208, v208
    v_cvt_pk_bf16_f32 v199, v206, v207
    v_exp_f32 v209, v209
    v_exp_f32 v210, v210
    v_cvt_pk_bf16_f32 v208, v208, v209
    v_mfma_f32_32x32x16_bf16 v[224:239], v[148:151], v[196:199], v[224:239]
    v_exp_f32 v211, v211
    v_exp_f32 v212, v212
    v_exp_f32 v213, v213
    v_mfma_f32_32x32x16_bf16 v[192:207], v[48:51], v[240:243], 0
    v_exp_f32 v214, v214
    v_exp_f32 v215, v215
    v_exp_f32 v216, v216
    v_cvt_pk_bf16_f32 v209, v210, v211
    v_exp_f32 v217, v217
    v_exp_f32 v218, v218
    v_exp_f32 v219, v219
    v_cvt_pk_bf16_f32 v210, v212, v213
    v_exp_f32 v220, v220
    v_exp_f32 v221, v221
    v_cvt_pk_bf16_f32 v211, v214, v215
    v_cvt_pk_bf16_f32 v212, v216, v217
    v_exp_f32 v222, v222
    v_mfma_f32_32x32x16_bf16 v[224:239], v[152:155], v[208:211], v[224:239]
    v_cvt_pk_bf16_f32 v213, v218, v219
    v_cvt_pk_bf16_f32 v214, v220, v221
    v_exp_f32 v223, v223
    s_waitcnt vmcnt(5)
    v_max3_u32 v254, v254, v160, v162
    v_max3_u32 v254, v254, v52, v54
    v_permlane16_swap_b32 v160, v164
    v_permlane16_swap_b32 v161, v165
    v_permlane16_swap_b32 v162, v166
    v_permlane16_swap_b32 v163, v167
    v_exp_f32 v192, v192
    v_cvt_pk_bf16_f32 v215, v222, v223
    v_exp_f32 v193, v193
    v_exp_f32 v194, v194
    v_cvt_pk_bf16_f32 v192, v192, v193
    v_mfma_f32_32x32x16_bf16 v[224:239], v[156:159], v[212:215], v[224:239]
    v_exp_f32 v195, v195
    v_exp_f32 v196, v196
    v_exp_f32 v197, v197
    v_mfma_f32_32x32x16_bf16 v[208:223], v[52:55], v[240:243], 0
    v_exp_f32 v198, v198
    v_exp_f32 v199, v199
    v_exp_f32 v200, v200
    v_cvt_pk_bf16_f32 v193, v194, v195
    v_exp_f32 v201, v201
    v_exp_f32 v202, v202
    v_exp_f32 v203, v203
    v_cvt_pk_bf16_f32 v194, v196, v197
    v_exp_f32 v204, v204
    v_exp_f32 v205, v205
    v_cvt_pk_bf16_f32 v195, v198, v199
    v_cvt_pk_bf16_f32 v196, v200, v201
    v_exp_f32 v206, v206
    v_mfma_f32_32x32x16_bf16 v[224:239], v[160:163], v[192:195], v[224:239]
    v_cvt_pk_bf16_f32 v197, v202, v203
    v_cvt_pk_bf16_f32 v198, v204, v205
    v_exp_f32 v207, v207
    s_waitcnt vmcnt(3)
    v_max3_u32 v254, v254, v168, v170
    v_max3_u32 v254, v254, v56, v58
    v_permlane16_swap_b32 v168, v172
    v_permlane16_swap_b32 v169, v173
    v_permlane16_swap_b32 v170, v174
    v_permlane16_swap_b32 v171, v175
    v_exp_f32 v208, v208
    v_cvt_pk_bf16_f32 v199, v206, v207
    v_exp_f32 v209, v209
    v_exp_f32 v210, v210
    v_cvt_pk_bf16_f32 v208, v208, v209
    v_mfma_f32_32x32x16_bf16 v[224:239], v[164:167], v[196:199], v[224:239]
    v_exp_f32 v211, v211
    v_exp_f32 v212, v212
    v_exp_f32 v213, v213
    v_mfma_f32_32x32x16_bf16 v[192:207], v[56:59], v[240:243], 0
    v_exp_f32 v214, v214
    v_exp_f32 v215, v215
    v_exp_f32 v216, v216
    v_cvt_pk_bf16_f32 v209, v210, v211
    v_exp_f32 v217, v217
    v_exp_f32 v218, v218
    v_exp_f32 v219, v219
    v_cvt_pk_bf16_f32 v210, v212, v213
    v_exp_f32 v220, v220
    v_exp_f32 v221, v221
    v_cvt_pk_bf16_f32 v211, v214, v215
    v_cvt_pk_bf16_f32 v212, v216, v217
    v_exp_f32 v222, v222
    v_mfma_f32_32x32x16_bf16 v[224:239], v[168:171], v[208:211], v[224:239]
    v_cvt_pk_bf16_f32 v213, v218, v219
    v_cvt_pk_bf16_f32 v214, v220, v221
    v_exp_f32 v223, v223
    s_waitcnt vmcnt(1)
    v_max3_u32 v254, v254, v176, v178
    v_max3_u32 v254, v254, v60, v62
    v_permlane16_swap_b32 v176, v180
    v_permlane16_swap_b32 v177, v181
    v_permlane16_swap_b32 v178, v182
    v_permlane16_swap_b32 v179, v183
    v_exp_f32 v192, v192
    v_cvt_pk_bf16_f32 v215, v222, v223
    v_exp_f32 v193, v193
    v_exp_f32 v194, v194
    v_cvt_pk_bf16_f32 v192, v192, v193
    v_mfma_f32_32x32x16_bf16 v[224:239], v[172:175], v[212:215], v[224:239]
    v_exp_f32 v195, v195
    v_exp_f32 v196, v196
    v_exp_f32 v197, v197
    v_mfma_f32_32x32x16_bf16 v[208:223], v[60:63], v[240:243], 0
    ds_read_b128 v[240:243], v246
    v_add_u32 v246, 1024, v246
    ds_read_b96 v[248:250], v251
    v_exp_f32 v198, v198
    v_exp_f32 v199, v199
    v_exp_f32 v200, v200
    v_cvt_pk_bf16_f32 v193, v194, v195
    v_exp_f32 v201, v201
    v_exp_f32 v202, v202
    v_exp_f32 v203, v203
    v_cvt_pk_bf16_f32 v194, v196, v197
    v_exp_f32 v204, v204
    v_exp_f32 v205, v205
    v_cvt_pk_bf16_f32 v195, v198, v199
    v_cvt_pk_bf16_f32 v196, v200, v201
    v_exp_f32 v206, v206
    v_mfma_f32_32x32x16_bf16 v[224:239], v[176:179], v[192:195], v[224:239]
    v_cvt_pk_bf16_f32 v197, v202, v203
    v_cvt_pk_bf16_f32 v198, v204, v205
    v_exp_f32 v207, v207
    s_waitcnt vmcnt(0)
    v_max3_u32 v254, v254, v184, v186
    v_permlane16_swap_b32 v184, v188
    v_permlane16_swap_b32 v185, v189
    v_permlane16_swap_b32 v186, v190
    v_permlane16_swap_b32 v187, v191
    v_exp_f32 v208, v208
    v_cvt_pk_bf16_f32 v199, v206, v207
    v_exp_f32 v209, v209
    v_exp_f32 v210, v210
    v_cvt_pk_bf16_f32 v208, v208, v209
    v_mfma_f32_32x32x16_bf16 v[224:239], v[180:183], v[196:199], v[224:239]
    v_exp_f32 v211, v211
    v_exp_f32 v212, v212
    s_waitcnt lgkmcnt(0)
    v_exp_f32 v213, v213
    v_mfma_f32_32x32x16_bf16 v[192:207], v[0:3], v[240:243], 0
    v_exp_f32 v214, v214
    v_exp_f32 v215, v215
    v_exp_f32 v216, v216
    v_cvt_pk_bf16_f32 v209, v210, v211
    v_exp_f32 v217, v217
    v_exp_f32 v218, v218
    v_exp_f32 v219, v219
    v_cvt_pk_bf16_f32 v210, v212, v213
    v_exp_f32 v220, v220
    v_exp_f32 v221, v221
    v_cvt_pk_bf16_f32 v211, v214, v215
    v_cvt_pk_bf16_f32 v212, v216, v217
    v_exp_f32 v222, v222
    v_mfma_f32_32x32x16_bf16 v[224:239], v[184:187], v[208:211], v[224:239]
    v_cvt_pk_bf16_f32 v213, v218, v219
    v_cvt_pk_bf16_f32 v214, v220, v221
    v_exp_f32 v223, v223
    v_cmp_eq_u32 vcc, -1, v254
    s_cbranch_vccnz L_redo
L_clean:
    v_cmp_ne_u32 vcc, 16, v250
    v_mul_f32 v248, v248, v249
    s_mov_b32 s63, 0
    s_cbranch_vccnz L_chk2
    v_cmp_nge_f32 vcc, 0x45700000, v248
    s_cbranch_vccz L_top
    s_branch L_slowgo
    .p2align 6
L_top:
    v_exp_f32 v192, v192
    v_cvt_pk_bf16_f32 v215, v222, v223
    v_exp_f32 v193, v193
    v_exp_f32 v194, v194
    v_cvt_pk_bf16_f32 v192, v192, v193
    v_mfma_f32_32x32x16_bf16 v[224:239], v[188:191], v[212:215], v[224:239]
    v_exp_f32 v195, v195
    v_exp_f32 v196, v196
    v_exp_f32 v197, v197
    v_mfma_f32_32x32x16_bf16 v[208:223], v[4:7], v[240:243], 0
    v_exp_f32 v198, v198
    v_exp_f32 v199, v199
    v_exp_f32 v200, v200
    v_cvt_pk_bf16_f32 v193, v194, v195
    v_exp_f32 v201, v201
    v_exp_f32 v202, v202
    v_exp_f32 v203, v203
    v_cvt_pk_bf16_f32 v194, v196, v197
    v_exp_f32 v204, v204
    ds_write2st64_b32 v244, v224, v225 offset0:0 offset1:4
    ds_write2st64_b32 v244, v226, v227 offset0:8 offset1:12
    ds_write2st64_b32 v244, v228, v229 offset0:16 offset1:20
    ds_write2st64_b32 v244, v230, v231 offset0:24 offset1:28
    ds_write2st64_b32 v244, v232, v245 offset0:32 offset1:36
    v_add_u32 v244, 10240, v244
    v_exp_f32 v205, v205
    v_cvt_pk_bf16_f32 v195, v198, v199
    v_cvt_pk_bf16_f32 v196, v200, v201
    v_exp_f32 v206, v206
    v_mfma_f32_32x32x16_bf16 v[224:239], v[64:67], v[192:195], 0
    v_cvt_pk_bf16_f32 v197, v202, v203
    v_cvt_pk_bf16_f32 v198, v204, v205
    v_exp_f32 v207, v207
    v_exp_f32 v208, v208
    v_cvt_pk_bf16_f32 v199, v206, v207
    v_exp_f32 v209, v209
    v_exp_f32 v210, v210
    v_cvt_pk_bf16_f32 v208, v208, v209
    v_mfma_f32_32x32x16_bf16 v[224:239], v[68:71], v[196:199], v[224:239]
    v_exp_f32 v211, v211
    v_exp_f32 v212, v212
    v_exp_f32 v213, v213
    v_mfma_f32_32x32x16_bf16 v[192:207], v[8:11], v[240:243], 0
    v_exp_f32 v214, v214
    v_exp_f32 v215, v215
    v_exp_f32 v216, v216
    v_cvt_pk_bf16_f32 v209, v210, v211
    v_exp_f32 v217, v217
    v_exp_f32 v218, v218
    v_exp_f32 v219, v219
    v_cvt_pk_bf16_f32 v210, v212, v213
    v_exp_f32 v220, v220
    v_exp_f32 v221, v221
    v_cvt_pk_bf16_f32 v211, v214, v215
    v_cvt_pk_bf16_f32 v212, v216, v217
    v_exp_f32 v222, v222
    v_mfma_f32_32x32x16_bf16 v[224:239], v[72:75], v[208:211], v[224:239]
    v_cvt_pk_bf16_f32 v213, v218, v219
    v_cvt_pk_bf16_f32 v214, v220, v221
    v_exp_f32 v223, v223
    v_exp_f32 v192, v192
    v_cvt_pk_bf16_f32 v215, v222, v223
    v_exp_f32 v193, v193
    v_exp_f32 v194, v194
    v_cvt_pk_bf16_f32 v192, v192, v193
    v_mfma_f32_32x32x16_bf16 v[224:239], v[76:79], v[212:215], v[224:239]
    v_exp_f32 v195, v195
    v_exp_f32 v196, v196
    v_exp_f32 v197, v197
    v_mfma_f32_32x32x16_bf16 v[208:223], v[12:15], v[240:243], 0
    v_exp_f32 v198, v198
    v_exp_f32 v199, v199
    v_exp_f32 v200, v200
    v_cvt_pk_bf16_f32 v193, v194, v195
    v_exp_f32 v201, v201
    v_exp_f32 v202, v202
    v_exp_f32 v203, v203
    v_cvt_pk_bf16_f32 v194, v196, v197
    v_exp_f32 v204, v204
    v_exp_f32 v205, v205
    v_cvt_pk_bf16_f32 v195, v198, v199
    v_cvt_pk_bf16_f32 v196, v200, v201
    v_exp_f32 v206, v206
    v_mfma_f32_32x32x16_bf16 v[224:239], v[80:83], v[192:195], v[224:239]
    v_cvt_pk_bf16_f32 v197, v202, v203
    v_cvt_pk_bf16_f32 v198, v204, v205
    v_exp_f32 v207, v207
    v_exp_f32 v208, v208
    v_cvt_pk_bf16_f32 v199, v206, v207
    v_exp_f32 v209, v209
    v_exp_f32 v210, v210
    v_cvt_pk_bf16_f32 v208, v208, v209
    v_mfma_f32_32x32x16_bf16 v[224:239], v[84:87], v[196:199], v[224:239]
    v_exp_f32 v211, v211
    v_exp_f32 v212, v212
    v_exp_f32 v213, v213
    v_mfma_f32_32x32x16_bf16 v[192:207], v[16:19], v[240:243], 0
    v_exp_f32 v214, v214
    v_exp_f32 v215, v215
    v_exp_f32 v216, v216
    v_cvt_pk_bf16_f32 v209, v210, v211
    v_exp_f32 v217, v217
    v_exp_f32 v218, v218
    v_exp_f32 v219, v219
    v_cvt_pk_bf16_f32 v210, v212, v213
    v_exp_f32 v220, v220
    v_exp_f32 v221, v221
    v_cvt_pk_bf16_f32 v211, v214, v215
    v_cvt_pk_bf16_f32 v212, v216, v217
    v_exp_f32 v222, v222
    v_mfma_f32_32x32x16_bf16 v[224:239], v[88:91], v[208:211], v[224:239]
    v_cvt_pk_bf16_f32 v213, v218, v219
    v_cvt_pk_bf16_f32 v214, v220, v221
    v_exp_f32 v223, v223
    v_exp_f32 v192, v192
    v_cvt_pk_bf16_f32 v215, v222, v223
    v_exp_f32 v193, v193
    v_exp_f32 v194, v194
    v_cvt_pk_bf16_f32 v192, v192, v193
    v_mfma_f32_32x32x16_bf16 v[224:239], v[92:95], v[212:215], v[224:239]
    v_exp_f32 v195, v195
    v_exp_f32 v196, v196
    v_exp_f32 v197, v197
    v_mfma_f32_32x32x16_bf16 v[208:223], v[20:23], v[240:243], 0
    v_exp_f32 v198, v198
    v_exp_f32 v199, v199
    v_exp_f32 v200, v200
    v_cvt_pk_bf16_f32 v193, v194, v195
    v_exp_f32 v201, v201
    v_exp_f32 v202, v202
    v_exp_f32 v203, v203
    v_cvt_pk_bf16_f32 v194, v196, v197
    v_exp_f32 v204, v204
    v_exp_f32 v205, v205
    v_cvt_pk_bf16_f32 v195, v198, v199
    v_cvt_pk_bf16_f32 v196, v200, v201
    v_exp_f32 v206, v206
    v_mfma_f32_32x32x16_bf16 v[224:239], v[96:99], v[192:195], v[224:239]
    v_cvt_pk_bf16_f32 v197, v202, v203
    v_cvt_pk_bf16_f32 v198, v204, v205
    v_exp_f32 v207, v207
    v_exp_f32 v208, v208
    v_cvt_pk_bf16_f32 v199, v206, v207
    v_exp_f32 v209, v209
    v_exp_f32 v210, v210
    v_cvt_pk_bf16_f32 v208, v208, v209
    v_mfma_f32_32x32x16_bf16 v[224:239], v[100:103], v[196:199], v[224:239]
    v_exp_f32 v211, v211
    v_exp_f32 v212, v212
    v_exp_f32 v213, v213
    v_mfma_f32_32x32x16_bf16 v[192:207], v[24:27], v[240:243], 0
    v_exp_f32 v214, v214
    v_exp_f32 v215, v215
    v_exp_f32 v216, v216
    v_cvt_pk_bf16_f32 v209, v210, v211
    v_exp_f32 v217, v217
    v_exp_f32 v218, v218
    v_exp_f32 v219, v219
    v_cvt_pk_bf16_f32 v210, v212, v213
    v_exp_f32 v220, v220
    v_exp_f32 v221, v221
    v_cvt_pk_bf16_f32 v211, v214, v215
    v_cvt_pk_bf16_f32 v212, v216, v217
    v_exp_f32 v222, v222
    v_mfma_f32_32x32x16_bf16 v[224:239], v[104:107], v[208:211], v[224:239]
    v_cvt_pk_bf16_f32 v213, v218, v219
    v_cvt_pk_bf16_f32 v214, v220, v221
    v_exp_f32 v223, v223
    v_exp_f32 v192, v192
    v_cvt_pk_bf16_f32 v215, v222, v223
    v_exp_f32 v193, v193
    v_exp_f32 v194, v194
    v_cvt_pk_bf16_f32 v192, v192, v193
    v_mfma_f32_32x32x16_bf16 v[224:239], v[108:111], v[212:215], v[224:239]
    v_exp_f32 v195, v195
    v_exp_f32 v196, v196
    v_exp_f32 v197, v197
    v_mfma_f32_32x32x16_bf16 v[208:223], v[28:31], v[240:243], 0
    v_exp_f32 v198, v198
    v_exp_f32 v199, v199
    v_exp_f32 v200, v200
    v_cvt_pk_bf16_f32 v193, v194, v195
    v_exp_f32 v201, v201
    v_exp_f32 v202, v202
    v_exp_f32 v203, v203
    v_cvt_pk_bf16_f32 v194, v196, v197
    v_exp_f32 v204, v204
    v_exp_f32 v205, v205
    v_cvt_pk_bf16_f32 v195, v198, v199
    v_cvt_pk_bf16_f32 v196, v200, v201
    v_exp_f32 v206, v206
    v_mfma_f32_32x32x16_bf16 v[224:239], v[112:115], v[192:195], v[224:239]
    v_cvt_pk_bf16_f32 v197, v202, v203
    v_cvt_pk_bf16_f32 v198, v204, v205
    v_exp_f32 v207, v207
    v_exp_f32 v208, v208
    v_cvt_pk_bf16_f32 v199, v206, v207
    v_exp_f32 v209, v209
    v_exp_f32 v210, v210
    v_cvt_pk_bf16_f32 v208, v208, v209
    v_mfma_f32_32x32x16_bf16 v[224:239], v[116:119], v[196:199], v[224:239]
    v_exp_f32 v211, v211
    v_exp_f32 v212, v212
    v_exp_f32 v213, v213
    v_mfma_f32_32x32x16_bf16 v[192:207], v[32:35], v[240:243], 0
    v_exp_f32 v214, v214
    v_exp_f32 v215, v215
    v_exp_f32 v216, v216
    v_cvt_pk_bf16_f32 v209, v210, v211
    v_exp_f32 v217, v217
    v_exp_f32 v218, v218
    v_exp_f32 v219, v219
    v_cvt_pk_bf16_f32 v210, v212, v213
    v_exp_f32 v220, v220
    v_exp_f32 v221, v221
    v_cvt_pk_bf16_f32 v211, v214, v215
    v_cvt_pk_bf16_f32 v212, v216, v217
    v_exp_f32 v222, v222
    v_mfma_f32_32x32x16_bf16 v[224:239], v[120:123], v[208:211], v[224:239]
    v_cvt_pk_bf16_f32 v213, v218, v219
    v_cvt_pk_bf16_f32 v214, v220, v221
    v_exp_f32 v223, v223
    v_exp_f32 v192, v192
    v_cvt_pk_bf16_f32 v215, v222, v223
    v_exp_f32 v193, v193
    v_exp_f32 v194, v194
    v_cvt_pk_bf16_f32 v192, v192, v193
    v_mfma_f32_32x32x16_bf16 v[224:239], v[124:127], v[212:215], v[224:239]
    v_exp_f32 v195, v195
    v_exp_f32 v196, v196
    v_exp_f32 v197, v197
    v_mfma_f32_32x32x16_bf16 v[208:223], v[36:39], v[240:243], 0
    v_exp_f32 v198, v198
    v_exp_f32 v199, v199
    v_exp_f32 v200, v200
    v_cvt_pk_bf16_f32 v193, v194, v195
    v_exp_f32 v201, v201
    v_exp_f32 v202, v202
    v_exp_f32 v203, v203
    v_cvt_pk_bf16_f32 v194, v196, v197
    v_exp_f32 v204, v204
    v_exp_f32 v205, v205
    v_cvt_pk_bf16_f32 v195, v198, v199
    v_cvt_pk_bf16_f32 v196, v200, v201
    v_exp_f32 v206, v206
    v_mfma_f32_32x32x16_bf16 v[224:239], v[128:131], v[192:195], v[224:239]
    v_cvt_pk_bf16_f32 v197, v202, v203
    v_cvt_pk_bf16_f32 v198, v204, v205
    v_exp_f32 v207, v207
    v_exp_f32 v208, v208
    v_cvt_pk_bf16_f32 v199, v206, v207
    v_exp_f32 v209, v209
    v_exp_f32 v210, v210
    v_cvt_pk_bf16_f32 v208, v208, v209
    v_mfma_f32_32x32x16_bf16 v[224:239], v[132:135], v[196:199], v[224:239]
    v_exp_f32 v211, v211
    v_exp_f32 v212, v212
    v_exp_f32 v213, v213
    v_mfma_f32_32x32x16_bf16 v[192:207], v[40:43], v[240:243], 0
    v_exp_f32 v214, v214
    v_exp_f32 v215, v215
    v_exp_f32 v216, v216
    v_cvt_pk_bf16_f32 v209, v210, v211
    v_exp_f32 v217, v217
    v_exp_f32 v218, v218
    v_exp_f32 v219, v219
    v_cvt_pk_bf16_f32 v210, v212, v213
    v_exp_f32 v220, v220
    v_exp_f32 v221, v221
    v_cvt_pk_bf16_f32 v211, v214, v215
    v_cvt_pk_bf16_f32 v212, v216, v217
    v_exp_f32 v222, v222
    v_mfma_f32_32x32x16_bf16 v[224:239], v[136:139], v[208:211], v[224:239]
    v_cvt_pk_bf16_f32 v213, v218, v219
    v_cvt_pk_bf16_f32 v214, v220, v221
    v_exp_f32 v223, v223
    v_exp_f32 v192, v192
    v_cvt_pk_bf16_f32 v215, v222, v223
    v_exp_f32 v193, v193
    v_exp_f32 v194, v194
    v_cvt_pk_bf16_f32 v192, v192, v193
    v_mfma_f32_32x32x16_bf16 v[224:239], v[140:143], v[212:215], v[224:239]
    v_exp_f32 v195, v195
    v_exp_f32 v196, v196
    v_exp_f32 v197, v197
    v_mfma_f32_32x32x16_bf16 v[208:223], v[44:47], v[240:243], 0
    v_exp_f32 v198, v198
    v_exp_f32 v199, v199
    v_exp_f32 v200, v200
    v_cvt_pk_bf16_f32 v193, v194, v195
    v_exp_f32 v201, v201
    v_exp_f32 v202, v202
    v_exp_f32 v203, v203
    v_cvt_pk_bf16_f32 v194, v196, v197
    v_exp_f32 v204, v204
    v_exp_f32 v205, v205
    v_cvt_pk_bf16_f32 v195, v198, v199
    v_cvt_pk_bf16_f32 v196, v200, v201
    v_exp_f32 v206, v206
    v_mfma_f32_32x32x16_bf16 v[224:239], v[144:147], v[192:195], v[224:239]
    v_cvt_pk_bf16_f32 v197, v202, v203
    v_cvt_pk_bf16_f32 v198, v204, v205
    v_exp_f32 v207, v207
    v_exp_f32 v208, v208
    v_cvt_pk_bf16_f32 v199, v206, v207
    v_exp_f32 v209, v209
    v_exp_f32 v210, v210
    v_cvt_pk_bf16_f32 v208, v208, v209
    v_mfma_f32_32x32x16_bf16 v[224:239], v[148:151], v[196:199], v[224:239]
    v_exp_f32 v211, v211
    v_exp_f32 v212, v212
    v_exp_f32 v213, v213
    v_mfma_f32_32x32x16_bf16 v[192:207], v[48:51], v[240:243], 0
    v_exp_f32 v214, v214
    v_exp_f32 v215, v215
    v_exp_f32 v216, v216
    v_cvt_pk_bf16_f32 v209, v210, v211
    v_exp_f32 v217, v217
    v_exp_f32 v218, v218
    v_exp_f32 v219, v219
    v_cvt_pk_bf16_f32 v210, v212, v213
    v_exp_f32 v220, v220
    v_exp_f32 v221, v221
    v_cvt_pk_bf16_f32 v211, v214, v215
    v_cvt_pk_bf16_f32 v212, v216, v217
    v_exp_f32 v222, v222
    v_mfma_f32_32x32x16_bf16 v[224:239], v[152:155], v[208:211], v[224:239]
    v_cvt_pk_bf16_f32 v213, v218, v219
    v_cvt_pk_bf16_f32 v214, v220, v221
    v_exp_f32 v223, v223
    v_exp_f32 v192, v192
    v_cvt_pk_bf16_f32 v215, v222, v223
    v_exp_f32 v193, v193
    v_exp_f32 v194, v194
    v_cvt_pk_bf16_f32 v192, v192, v193
    v_mfma_f32_32x32x16_bf16 v[224:239], v[156:159], v[212:215], v[224:239]
    v_exp_f32 v195, v195
    v_exp_f32 v196, v196
    v_exp_f32 v197, v197
    v_mfma_f32_32x32x16_bf16 v[208:223], v[52:55], v[240:243], 0
    v_exp_f32 v198, v198
    v_exp_f32 v199, v199
    v_exp_f32 v200, v200
    v_cvt_pk_bf16_f32 v193, v194, v195
    v_exp_f32 v201, v201
    v_exp_f32 v202, v202
    v_exp_f32 v203, v203
    v_cvt_pk_bf16_f32 v194, v196, v197
    v_exp_f32 v204, v204
    v_exp_f32 v205, v205
    v_cvt_pk_bf16_f32 v195, v198, v199
    v_cvt_pk_bf16_f32 v196, v200, v201
    v_exp_f32 v206, v206
    v_mfma_f32_32x32x16_bf16 v[224:239], v[160:163], v[192:195], v[224:239]
    v_cvt_pk_bf16_f32 v197, v202, v203
    v_cvt_pk_bf16_f32 v198, v204, v205
    v_exp_f32 v207, v207
    v_exp_f32 v208, v208
    v_cvt_pk_bf16_f32 v199, v206, v207
    v_exp_f32 v209, v209
    v_exp_f32 v210, v210
    v_cvt_pk_bf16_f32 v208, v208, v209
    v_mfma_f32_32x32x16_bf16 v[224:239], v[164:167], v[196:199], v[224:239]
    v_exp_f32 v211, v211
    v_exp_f32 v212, v212
    v_exp_f32 v213, v213
    v_mfma_f32_32x32x16_bf16 v[192:207], v[56:59], v[240:243], 0
    v_exp_f32 v214, v214
    v_exp_f32 v215, v215
    v_exp_f32 v216, v216
    v_cvt_pk_bf16_f32 v209, v210, v211
    v_exp_f32 v217, v217
    v_exp_f32 v218, v218
    v_exp_f32 v219, v219
    v_cvt_pk_bf16_f32 v210, v212, v213
    v_exp_f32 v220, v220
    v_exp_f32 v221, v221
    v_cvt_pk_bf16_f32 v211, v214, v215
    v_cvt_pk_bf16_f32 v212, v216, v217
    v_exp_f32 v222, v222
    v_mfma_f32_32x32x16_bf16 v[224:239], v[168:171], v[208:211], v[224:239]
    v_cvt_pk_bf16_f32 v213, v218, v219
    v_cvt_pk_bf16_f32 v214, v220, v221
    v_exp_f32 v223, v223
    v_exp_f32 v192, v192
    v_cvt_pk_bf16_f32 v215, v222, v223
    v_exp_f32 v193, v193
    v_exp_f32 v194, v194
    v_cvt_pk_bf16_f32 v192, v192, v193
    v_mfma_f32_32x32x16_bf16 v[224:239], v[172:175], v[212:215], v[224:239]
    v_exp_f32 v195, v195
    v_exp_f32 v196, v196
    v_exp_f32 v197, v197
    v_mfma_f32_32x32x16_bf16 v[208:223], v[60:63], v[240:243], 0
    ds_read_b128 v[240:243], v246
    v_add_u32 v246, 1024, v246
    v_exp_f32 v198, v198
    v_exp_f32 v199, v199
    v_exp_f32 v200, v200
    v_cvt_pk_bf16_f32 v193, v194, v195
    v_exp_f32 v201, v201
    v_exp_f32 v202, v202
    v_exp_f32 v203, v203
    v_cvt_pk_bf16_f32 v194, v196, v197
    v_exp_f32 v204, v204
    v_exp_f32 v205, v205
    v_cvt_pk_bf16_f32 v195, v198, v199
    v_cvt_pk_bf16_f32 v196, v200, v201
    v_exp_f32 v206, v206
    v_mfma_f32_32x32x16_bf16 v[224:239], v[176:179], v[192:195], v[224:239]
    v_cvt_pk_bf16_f32 v197, v202, v203
    v_cvt_pk_bf16_f32 v198, v204, v205
    v_exp_f32 v207, v207
    v_exp_f32 v208, v208
    v_cvt_pk_bf16_f32 v199, v206, v207
    v_exp_f32 v209, v209
    v_exp_f32 v210, v210
    v_cvt_pk_bf16_f32 v208, v208, v209
    v_mfma_f32_32x32x16_bf16 v[224:239], v[180:183], v[196:199], v[224:239]
    v_exp_f32 v211, v211
    v_exp_f32 v212, v212
    s_waitcnt lgkmcnt(0)
    v_exp_f32 v213, v213
    v_mfma_f32_32x32x16_bf16 v[192:207], v[0:3], v[240:243], 0
    v_exp_f32 v214, v214
    v_exp_f32 v215, v215
    v_exp_f32 v216, v216
    v_cvt_pk_bf16_f32 v209, v210, v211
    v_exp_f32 v217, v217
    v_exp_f32 v218, v218
    v_exp_f32 v219, v219
    v_cvt_pk_bf16_f32 v210, v212, v213
    v_exp_f32 v220, v220
    v_exp_f32 v221, v221
    v_cvt_pk_bf16_f32 v211, v214, v215
    v_cvt_pk_bf16_f32 v212, v216, v217
    v_exp_f32 v222, v222
    v_mfma_f32_32x32x16_bf16 v[224:239], v[184:187], v[208:211], v[224:239]
    v_cvt_pk_bf16_f32 v213, v218, v219
    v_cvt_pk_bf16_f32 v214, v220, v221
    s_bitcmp1_b32 s64, s62
    v_exp_f32 v223, v223
    s_cbranch_scc1 L_check
    s_sub_u32 s62, s62, 1
    s_cbranch_scc0 L_top
    v_cvt_pk_bf16_f32 v215, v222, v223
    s_nop 1
    v_mfma_f32_32x32x16_bf16 v[224:239], v[188:191], v[212:215], v[224:239]
L_last:
    s_lshl_b32 s60, s50, 10
    s_add_u32 s60, s60, 51200
    v_lshlrev_b32 v247, 4, v255
    v_add_u32 v247, s60, v247
    s_nop 7
    ds_write_b128 v247, v[224:227]
    ds_write_b128 v247, v[228:231] offset:4096
    ds_write_b32 v244, v232 offset:8192
    s_waitcnt lgkmcnt(0)
    s_barrier
    s_endpgm
L_kvlate:
    s_sleep 4
    buffer_load_dwordx2 v[248:249], v247, s[44:47], s61 offen sc1
    s_add_u32 s63, s63, 1
    s_cmp_gt_u32 s63, 1000000
    s_cbranch_scc1 L_kvlate2
    s_waitcnt vmcnt(0)
    v_cmp_ne_u32 vcc, s53, v248
    s_cbranch_vccnz L_kvlate
L_kvlate2:
    s_mov_b32 s14, 16777216
    buffer_load_dwordx4 v[0:3], v250, s[12:15], s8 offen offset:0 sc1
    buffer_load_dwordx4 v[64:67], v252, s[12:15], s8 offen offset:0 sc1
    buffer_load_dwordx4 v[4:7], v250, s[12:15], s8 offen offset:1024 sc1
    buffer_load_dwordx4 v[72:75], v252, s[12:15], s8 offen offset:1024 sc1
    buffer_load_dwordx4 v[8:11], v250, s[12:15], s8 offen offset:2048 sc1
    buffer_load_dwordx4 v[80:83], v252, s[12:15], s8 offen offset:2048 sc1
    buffer_load_dwordx4 v[12:15], v250, s[12:15], s8 offen offset:3072 sc1
    buffer_load_dwordx4 v[88:91], v252, s[12:15], s8 offen offset:3072 sc1
    buffer_load_dwordx4 v[16:19], v250, s[12:15], s9 offen offset:0 sc1
    buffer_load_dwordx4 v[96:99], v252, s[12:15], s9 offen offset:0 sc1
    s_branch L_kvgo
L_redo:
    s_add_u32 s65, s65, 1
    s_cmp_gt_u32 s65, 1000
    s_cbranch_scc1 L_clean
    v_and_b32 v250, 11, v255
    v_cmp_eq_u32 vcc, 0, v250
    v_mov_b32 v249, 0x3f803f80
    v_lshlrev_b32 v250, 4, v255
    v_cndmask_b32 v68, 0, v249, vcc
    v_add_u32 v246, 151552, v250
    v_mov_b32 v69, v68
    s_nop 7
    s_nop 7
    ds_read_b128 v[240:243], v246
    v_add_u32 v246, 1024, v246
    v_mov_b64 v[70:71], v[68:69]
    v_mov_b64 v[76:77], v[68:69]
    v_mov_b64 v[78:79], v[68:69]
    v_mov_b64 v[84:85], v[68:69]
    v_mov_b64 v[86:87], v[68:69]
    v_mov_b64 v[92:93], v[68:69]
    v_mov_b64 v[94:95], v[68:69]
    v_mov_b64 v[100:101], v[68:69]
    v_mov_b64 v[102:103], v[68:69]
    v_mov_b64 v[108:109], v[68:69]
    v_mov_b64 v[110:111], v[68:69]
    v_mov_b64 v[116:117], v[68:69]
    v_mov_b64 v[118:119], v[68:69]
    v_mov_b64 v[124:125], v[68:69]
    v_mov_b64 v[126:127], v[68:69]
    v_mov_b64 v[132:133], v[68:69]
    v_mov_b64 v[134:135], v[68:69]
    v_mov_b64 v[140:141], v[68:69]
    v_mov_b64 v[142:143], v[68:69]
    v_mov_b64 v[148:149], v[68:69]
    v_mov_b64 v[150:151], v[68:69]
    v_mov_b64 v[156:157], v[68:69]
    v_mov_b64 v[158:159], v[68:69]
    v_mov_b64 v[164:165], v[68:69]
    v_mov_b64 v[166:167], v[68:69]
    v_mov_b64 v[172:173], v[68:69]
    v_mov_b64 v[174:175], v[68:69]
    v_mov_b64 v[180:181], v[68:69]
    v_mov_b64 v[182:183], v[68:69]
    v_mov_b64 v[188:189], v[68:69]
    v_mov_b64 v[190:191], v[68:69]
    buffer_load_dwordx4 v[0:3], v250, s[12:15], s8 offen offset:0 sc1
    buffer_load_dwordx4 v[64:67], v252, s[12:15], s8 offen offset:0 sc1
    buffer_load_dwordx4 v[4:7], v250, s[12:15], s8 offen offset:1024 sc1
    buffer_load_dwordx4 v[72:75], v252, s[12:15], s8 offen offset:1024 sc1
    buffer_load_dwordx4 v[8:11], v250, s[12:15], s8 offen offset:2048 sc1
    buffer_load_dwordx4 v[80:83], v252, s[12:15], s8 offen offset:2048 sc1
    buffer_load_dwordx4 v[12:15], v250, s[12:15], s8 offen offset:3072 sc1
    buffer_load_dwordx4 v[88:91], v252, s[12:15], s8 offen offset:3072 sc1
    buffer_load_dwordx4 v[16:19], v250, s[12:15], s9 offen offset:0 sc1
    buffer_load_dwordx4 v[96:99], v252, s[12:15], s9 offen offset:0 sc1
    s_waitcnt lgkmcnt(0)
    s_branch L_qk0
L_check:
    s_mov_b32 s63, 0
    s_sub_u32 s62, s62, 1
    s_cmp_eq_u32 s62, 4
    s_cselect_b32 s60, 4, 12
    s_cselect_b32 s61, 151552, 0
    s_add_u32 s60, s60, 160016
    v_mov_b32 v249, s60
L_xw:
    ds_read_b32 v248, v249
    s_add_u32 s63, s63, 1
    s_cmp_gt_u32 s63, 1000000
    s_cbranch_scc1 L_xw_x
    s_waitcnt lgkmcnt(0)
    v_cmp_ne_u32 vcc, 4, v248
    s_cbranch_vccnz L_xw
L_xw_x:
    v_subrev_u32 v244, s61, v244
    s_branch L_top
L_chk2:
    ds_read_b96 v[248:250], v251
    s_add_u32 s63, s63, 1
    s_cmp_gt_u32 s63, 1000000
    s_cbranch_scc1 L_chk3
    s_waitcnt lgkmcnt(0)
    v_cmp_ne_u32 vcc, 16, v250
    s_cbranch_vccnz L_chk2
L_chk3:
    v_mul_f32 v248, v248, v249
    v_cmp_nge_f32 vcc, 0x45700000, v248
    s_cbranch_vccz L_top
L_slowgo:
    v_lshlrev_b32 v246, 4, v255
    v_add_u32 v246, 151552, v246
    v_and_b32 v247, 31, v255
    v_lshlrev_b32 v247, 2, v247
    v_add_u32 v247, 160768, v247
    v_mov_b32 v251, 160064
    s_mov_b32 s62, 8
L_slow:
    ds_read_b128 v[240:243], v246
    v_add_u32 v246, 1024, v246
    v_mov_b32 v248, 0xff800000
    s_waitcnt lgkmcnt(0)
    v_mfma_f32_32x32x16_bf16 v[192:207], v[0:3], v[240:243], 0
    s_nop 11
    v_max3_f32 v248, v248, v192, v193
    v_max3_f32 v248, v248, v194, v195
    v_max3_f32 v248, v248, v196, v197
    v_max3_f32 v248, v248, v198, v199
    v_max3_f32 v248, v248, v200, v201
    v_max3_f32 v248, v248, v202, v203
    v_max3_f32 v248, v248, v204, v205
    v_max3_f32 v248, v248, v206, v207
    v_mfma_f32_32x32x16_bf16 v[192:207], v[4:7], v[240:243], 0
    s_nop 11
    v_max3_f32 v248, v248, v192, v193
    v_max3_f32 v248, v248, v194, v195
    v_max3_f32 v248, v248, v196, v197
    v_max3_f32 v248, v248, v198, v199
    v_max3_f32 v248, v248, v200, v201
    v_max3_f32 v248, v248, v202, v203
    v_max3_f32 v248, v248, v204, v205
    v_max3_f32 v248, v248, v206, v207
    v_mfma_f32_32x32x16_bf16 v[192:207], v[8:11], v[240:243], 0
    s_nop 11
    v_max3_f32 v248, v248, v192, v193
    v_max3_f32 v248, v248, v194, v195
    v_max3_f32 v248, v248, v196, v197
    v_max3_f32 v248, v248, v198, v199
    v_max3_f32 v248, v248, v200, v201
    v_max3_f32 v248, v248, v202, v203
    v_max3_f32 v248, v248, v204, v205
    v_max3_f32 v248, v248, v206, v207
    v_mfma_f32_32x32x16_bf16 v[192:207], v[12:15], v[240:243], 0
    s_nop 11
    v_max3_f32 v248, v248, v192, v193
    v_max3_f32 v248, v248, v194, v195
    v_max3_f32 v248, v248, v196, v197
    v_max3_f32 v248, v248, v198, v199
    v_max3_f32 v248, v248, v200, v201
    v_max3_f32 v248, v248, v202, v203
    v_max3_f32 v248, v248, v204, v205
    v_max3_f32 v248, v248, v206, v207
    v_mfma_f32_32x32x16_bf16 v[192:207], v[16:19], v[240:243], 0
    s_nop 11
    v_max3_f32 v248, v248, v192, v193
    v_max3_f32 v248, v248, v194, v195
    v_max3_f32 v248, v248, v196, v197
    v_max3_f32 v248, v248, v198, v199
    v_max3_f32 v248, v248, v200, v201
    v_max3_f32 v248, v248, v202, v203
    v_max3_f32 v248, v248, v204, v205
    v_max3_f32 v248, v248, v206, v207
    v_mfma_f32_32x32x16_bf16 v[192:207], v[20:23], v[240:243], 0
    s_nop 11
    v_max3_f32 v248, v248, v192, v193
    v_max3_f32 v248, v248, v194, v195
    v_max3_f32 v248, v248, v196, v197
    v_max3_f32 v248, v248, v198, v199
    v_max3_f32 v248, v248, v200, v201
    v_max3_f32 v248, v248, v202, v203
    v_max3_f32 v248, v248, v204, v205
    v_max3_f32 v248, v248, v206, v207
    v_mfma_f32_32x32x16_bf16 v[192:207], v[24:27], v[240:243], 0
    s_nop 11
    v_max3_f32 v248, v248, v192, v193
    v_max3_f32 v248, v248, v194, v195
    v_max3_f32 v248, v248, v196, v197
    v_max3_f32 v248, v248, v198, v199
    v_max3_f32 v248, v248, v200, v201
    v_max3_f32 v248, v248, v202, v203
    v_max3_f32 v248, v248, v204, v205
    v_max3_f32 v248, v248, v206, v207
    v_mfma_f32_32x32x16_bf16 v[192:207], v[28:31], v[240:243], 0
    s_nop 11
    v_max3_f32 v248, v248, v192, v193
    v_max3_f32 v248, v248, v194, v195
    v_max3_f32 v248, v248, v196, v197
    v_max3_f32 v248, v248, v198, v199
    v_max3_f32 v248, v248, v200, v201
    v_max3_f32 v248, v248, v202, v203
    v_max3_f32 v248, v248, v204, v205
    v_max3_f32 v248, v248, v206, v207
    v_mfma_f32_32x32x16_bf16 v[192:207], v[32:35], v[240:243], 0
    s_nop 11
    v_max3_f32 v248, v248, v192, v193
    v_max3_f32 v248, v248, v194, v195
    v_max3_f32 v248, v248, v196, v197
    v_max3_f32 v248, v248, v198, v199
    v_max3_f32 v248, v248, v200, v201
    v_max3_f32 v248, v248, v202, v203
    v_max3_f32 v248, v248, v204, v205
    v_max3_f32 v248, v248, v206, v207
    v_mfma_f32_32x32x16_bf16 v[192:207], v[36:39], v[240:243], 0
    s_nop 11
    v_max3_f32 v248, v248, v192, v193
    v_max3_f32 v248, v248, v194, v195
    v_max3_f32 v248, v248, v196, v197
    v_max3_f32 v248, v248, v198, v199
    v_max3_f32 v248, v248, v200, v201
    v_max3_f32 v248, v248, v202, v203
    v_max3_f32 v248, v248, v204, v205
    v_max3_f32 v248, v248, v206, v207
    v_mfma_f32_32x32x16_bf16 v[192:207], v[40:43], v[240:243], 0
    s_nop 11
    v_max3_f32 v248, v248, v192, v193
    v_max3_f32 v248, v248, v194, v195
    v_max3_f32 v248, v248, v196, v197
    v_max3_f32 v248, v248, v198, v199
    v_max3_f32 v248, v248, v200, v201
    v_max3_f32 v248, v248, v202, v203
    v_max3_f32 v248, v248, v204, v205
    v_max3_f32 v248, v248, v206, v207
    v_mfma_f32_32x32x16_bf16 v[192:207], v[44:47], v[240:243], 0
    s_nop 11
    v_max3_f32 v248, v248, v192, v193
    v_max3_f32 v248, v248, v194, v195
    v_max3_f32 v248, v248, v196, v197
    v_max3_f32 v248, v248, v198, v199
    v_max3_f32 v248, v248, v200, v201
    v_max3_f32 v248, v248, v202, v203
    v_max3_f32 v248, v248, v204, v205
    v_max3_f32 v248, v248, v206, v207
    v_mfma_f32_32x32x16_bf16 v[192:207], v[48:51], v[240:243], 0
    s_nop 11
    v_max3_f32 v248, v248, v192, v193
    v_max3_f32 v248, v248, v194, v195
    v_max3_f32 v248, v248, v196, v197
    v_max3_f32 v248, v248, v198, v199
    v_max3_f32 v248, v248, v200, v201
    v_max3_f32 v248, v248, v202, v203
    v_max3_f32 v248, v248, v204, v205
    v_max3_f32 v248, v248, v206, v207
    v_mfma_f32_32x32x16_bf16 v[192:207], v[52:55], v[240:243], 0
    s_nop 11
    v_max3_f32 v248, v248, v192, v193
    v_max3_f32 v248, v248, v194, v195
    v_max3_f32 v248, v248, v196, v197
    v_max3_f32 v248, v248, v198, v199
    v_max3_f32 v248, v248, v200, v201
    v_max3_f32 v248, v248, v202, v203
    v_max3_f32 v248, v248, v204, v205
    v_max3_f32 v248, v248, v206, v207
    v_mfma_f32_32x32x16_bf16 v[192:207], v[56:59], v[240:243], 0
    s_nop 11
    v_max3_f32 v248, v248, v192, v193
    v_max3_f32 v248, v248, v194, v195
    v_max3_f32 v248, v248, v196, v197
    v_max3_f32 v248, v248, v198, v199
    v_max3_f32 v248, v248, v200, v201
    v_max3_f32 v248, v248, v202, v203
    v_max3_f32 v248, v248, v204, v205
    v_max3_f32 v248, v248, v206, v207
    v_mfma_f32_32x32x16_bf16 v[192:207], v[60:63], v[240:243], 0
    s_nop 11
    v_max3_f32 v248, v248, v192, v193
    v_max3_f32 v248, v248, v194, v195
    v_max3_f32 v248, v248, v196, v197
    v_max3_f32 v248, v248, v198, v199
    v_max3_f32 v248, v248, v200, v201
    v_max3_f32 v248, v248, v202, v203
    v_max3_f32 v248, v248, v204, v205
    v_max3_f32 v248, v248, v206, v207
    ds_max_f32 v247, v248
    s_mov_b64 exec, 1
    ds_add_u32 v251, v253
    s_mov_b64 exec, -1
    s_mov_b32 s63, 0
L_slow2:
    s_sleep 1
    ds_read_b32 v249, v251
    s_add_u32 s63, s63, 1
    s_cmp_gt_u32 s63, 1000000
    s_cbranch_scc1 L_slow3
    s_waitcnt lgkmcnt(0)
    v_cmp_ne_u32 vcc, 4, v249
    s_cbranch_vccnz L_slow2
L_slow3:
    ds_read_b32 v248, v247
    v_add_u32 v247, 128, v247
    v_add_u32 v251, 4, v251
    s_waitcnt lgkmcnt(0)
    v_mfma_f32_32x32x16_bf16 v[192:207], v[0:3], v[240:243], 0
    s_nop 11
    v_sub_f32 v192, v192, v248
    v_sub_f32 v193, v193, v248
    v_sub_f32 v194, v194, v248
    v_sub_f32 v195, v195, v248
    v_sub_f32 v196, v196, v248
    v_sub_f32 v197, v197, v248
    v_sub_f32 v198, v198, v248
    v_sub_f32 v199, v199, v248
    v_sub_f32 v200, v200, v248
    v_sub_f32 v201, v201, v248
    v_sub_f32 v202, v202, v248
    v_sub_f32 v203, v203, v248
    v_sub_f32 v204, v204, v248
    v_sub_f32 v205, v205, v248
    v_sub_f32 v206, v206, v248
    v_sub_f32 v207, v207, v248
    v_exp_f32 v192, v192
    v_exp_f32 v193, v193
    v_exp_f32 v194, v194
    v_exp_f32 v195, v195
    v_exp_f32 v196, v196
    v_exp_f32 v197, v197
    v_exp_f32 v198, v198
    v_exp_f32 v199, v199
    v_exp_f32 v200, v200
    v_exp_f32 v201, v201
    v_exp_f32 v202, v202
    v_exp_f32 v203, v203
    v_exp_f32 v204, v204
    v_exp_f32 v205, v205
    v_exp_f32 v206, v206
    v_exp_f32 v207, v207
    s_nop 0
    v_cvt_pk_bf16_f32 v208, v192, v193
    v_cvt_pk_bf16_f32 v209, v194, v195
    v_cvt_pk_bf16_f32 v210, v196, v197
    v_cvt_pk_bf16_f32 v211, v198, v199
    v_cvt_pk_bf16_f32 v212, v200, v201
    v_cvt_pk_bf16_f32 v213, v202, v203
    v_cvt_pk_bf16_f32 v214, v204, v205
    v_cvt_pk_bf16_f32 v215, v206, v207
    s_nop 1
    v_mfma_f32_32x32x16_bf16 v[224:239], v[64:67], v[208:211], 0
    v_mfma_f32_32x32x16_bf16 v[224:239], v[68:71], v[212:215], v[224:239]
    v_mfma_f32_32x32x16_bf16 v[192:207], v[4:7], v[240:243], 0
    s_nop 11
    v_sub_f32 v192, v192, v248
    v_sub_f32 v193, v193, v248
    v_sub_f32 v194, v194, v248
    v_sub_f32 v195, v195, v248
    v_sub_f32 v196, v196, v248
    v_sub_f32 v197, v197, v248
    v_sub_f32 v198, v198, v248
    v_sub_f32 v199, v199, v248
    v_sub_f32 v200, v200, v248
    v_sub_f32 v201, v201, v248
    v_sub_f32 v202, v202, v248
    v_sub_f32 v203, v203, v248
    v_sub_f32 v204, v204, v248
    v_sub_f32 v205, v205, v248
    v_sub_f32 v206, v206, v248
    v_sub_f32 v207, v207, v248
    v_exp_f32 v192, v192
    v_exp_f32 v193, v193
    v_exp_f32 v194, v194
    v_exp_f32 v195, v195
    v_exp_f32 v196, v196
    v_exp_f32 v197, v197
    v_exp_f32 v198, v198
    v_exp_f32 v199, v199
    v_exp_f32 v200, v200
    v_exp_f32 v201, v201
    v_exp_f32 v202, v202
    v_exp_f32 v203, v203
    v_exp_f32 v204, v204
    v_exp_f32 v205, v205
    v_exp_f32 v206, v206
    v_exp_f32 v207, v207
    s_nop 0
    v_cvt_pk_bf16_f32 v208, v192, v193
    v_cvt_pk_bf16_f32 v209, v194, v195
    v_cvt_pk_bf16_f32 v210, v196, v197
    v_cvt_pk_bf16_f32 v211, v198, v199
    v_cvt_pk_bf16_f32 v212, v200, v201
    v_cvt_pk_bf16_f32 v213, v202, v203
    v_cvt_pk_bf16_f32 v214, v204, v205
    v_cvt_pk_bf16_f32 v215, v206, v207
    s_nop 1
    v_mfma_f32_32x32x16_bf16 v[224:239], v[72:75], v[208:211], v[224:239]
    v_mfma_f32_32x32x16_bf16 v[224:239], v[76:79], v[212:215], v[224:239]
    v_mfma_f32_32x32x16_bf16 v[192:207], v[8:11], v[240:243], 0
    s_nop 11
    v_sub_f32 v192, v192, v248
    v_sub_f32 v193, v193, v248
    v_sub_f32 v194, v194, v248
    v_sub_f32 v195, v195, v248
    v_sub_f32 v196, v196, v248
    v_sub_f32 v197, v197, v248
    v_sub_f32 v198, v198, v248
    v_sub_f32 v199, v199, v248
    v_sub_f32 v200, v200, v248
    v_sub_f32 v201, v201, v248
    v_sub_f32 v202, v202, v248
    v_sub_f32 v203, v203, v248
    v_sub_f32 v204, v204, v248
    v_sub_f32 v205, v205, v248
    v_sub_f32 v206, v206, v248
    v_sub_f32 v207, v207, v248
    v_exp_f32 v192, v192
    v_exp_f32 v193, v193
    v_exp_f32 v194, v194
    v_exp_f32 v195, v195
    v_exp_f32 v196, v196
    v_exp_f32 v197, v197
    v_exp_f32 v198, v198
    v_exp_f32 v199, v199
    v_exp_f32 v200, v200
    v_exp_f32 v201, v201
    v_exp_f32 v202, v202
    v_exp_f32 v203, v203
    v_exp_f32 v204, v204
    v_exp_f32 v205, v205
    v_exp_f32 v206, v206
    v_exp_f32 v207, v207
    s_nop 0
    v_cvt_pk_bf16_f32 v208, v192, v193
    v_cvt_pk_bf16_f32 v209, v194, v195
    v_cvt_pk_bf16_f32 v210, v196, v197
    v_cvt_pk_bf16_f32 v211, v198, v199
    v_cvt_pk_bf16_f32 v212, v200, v201
    v_cvt_pk_bf16_f32 v213, v202, v203
    v_cvt_pk_bf16_f32 v214, v204, v205
    v_cvt_pk_bf16_f32 v215, v206, v207
    s_nop 1
    v_mfma_f32_32x32x16_bf16 v[224:239], v[80:83], v[208:211], v[224:239]
    v_mfma_f32_32x32x16_bf16 v[224:239], v[84:87], v[212:215], v[224:239]
    v_mfma_f32_32x32x16_bf16 v[192:207], v[12:15], v[240:243], 0
    s_nop 11
    v_sub_f32 v192, v192, v248
    v_sub_f32 v193, v193, v248
    v_sub_f32 v194, v194, v248
    v_sub_f32 v195, v195, v248
    v_sub_f32 v196, v196, v248
    v_sub_f32 v197, v197, v248
    v_sub_f32 v198, v198, v248
    v_sub_f32 v199, v199, v248
    v_sub_f32 v200, v200, v248
    v_sub_f32 v201, v201, v248
    v_sub_f32 v202, v202, v248
    v_sub_f32 v203, v203, v248
    v_sub_f32 v204, v204, v248
    v_sub_f32 v205, v205, v248
    v_sub_f32 v206, v206, v248
    v_sub_f32 v207, v207, v248
    v_exp_f32 v192, v192
    v_exp_f32 v193, v193
    v_exp_f32 v194, v194
    v_exp_f32 v195, v195
    v_exp_f32 v196, v196
    v_exp_f32 v197, v197
    v_exp_f32 v198, v198
    v_exp_f32 v199, v199
    v_exp_f32 v200, v200
    v_exp_f32 v201, v201
    v_exp_f32 v202, v202
    v_exp_f32 v203, v203
    v_exp_f32 v204, v204
    v_exp_f32 v205, v205
    v_exp_f32 v206, v206
    v_exp_f32 v207, v207
    s_nop 0
    v_cvt_pk_bf16_f32 v208, v192, v193
    v_cvt_pk_bf16_f32 v209, v194, v195
    v_cvt_pk_bf16_f32 v210, v196, v197
    v_cvt_pk_bf16_f32 v211, v198, v199
    v_cvt_pk_bf16_f32 v212, v200, v201
    v_cvt_pk_bf16_f32 v213, v202, v203
    v_cvt_pk_bf16_f32 v214, v204, v205
    v_cvt_pk_bf16_f32 v215, v206, v207
    s_nop 1
    v_mfma_f32_32x32x16_bf16 v[224:239], v[88:91], v[208:211], v[224:239]
    v_mfma_f32_32x32x16_bf16 v[224:239], v[92:95], v[212:215], v[224:239]
    v_mfma_f32_32x32x16_bf16 v[192:207], v[16:19], v[240:243], 0
    s_nop 11
    v_sub_f32 v192, v192, v248
    v_sub_f32 v193, v193, v248
    v_sub_f32 v194, v194, v248
    v_sub_f32 v195, v195, v248
    v_sub_f32 v196, v196, v248
    v_sub_f32 v197, v197, v248
    v_sub_f32 v198, v198, v248
    v_sub_f32 v199, v199, v248
    v_sub_f32 v200, v200, v248
    v_sub_f32 v201, v201, v248
    v_sub_f32 v202, v202, v248
    v_sub_f32 v203, v203, v248
    v_sub_f32 v204, v204, v248
    v_sub_f32 v205, v205, v248
    v_sub_f32 v206, v206, v248
    v_sub_f32 v207, v207, v248
    v_exp_f32 v192, v192
    v_exp_f32 v193, v193
    v_exp_f32 v194, v194
    v_exp_f32 v195, v195
    v_exp_f32 v196, v196
    v_exp_f32 v197, v197
    v_exp_f32 v198, v198
    v_exp_f32 v199, v199
    v_exp_f32 v200, v200
    v_exp_f32 v201, v201
    v_exp_f32 v202, v202
    v_exp_f32 v203, v203
    v_exp_f32 v204, v204
    v_exp_f32 v205, v205
    v_exp_f32 v206, v206
    v_exp_f32 v207, v207
    s_nop 0
    v_cvt_pk_bf16_f32 v208, v192, v193
    v_cvt_pk_bf16_f32 v209, v194, v195
    v_cvt_pk_bf16_f32 v210, v196, v197
    v_cvt_pk_bf16_f32 v211, v198, v199
    v_cvt_pk_bf16_f32 v212, v200, v201
    v_cvt_pk_bf16_f32 v213, v202, v203
    v_cvt_pk_bf16_f32 v214, v204, v205
    v_cvt_pk_bf16_f32 v215, v206, v207
    s_nop 1
    v_mfma_f32_32x32x16_bf16 v[224:239], v[96:99], v[208:211], v[224:239]
    v_mfma_f32_32x32x16_bf16 v[224:239], v[100:103], v[212:215], v[224:239]
    v_mfma_f32_32x32x16_bf16 v[192:207], v[20:23], v[240:243], 0
    s_nop 11
    v_sub_f32 v192, v192, v248
    v_sub_f32 v193, v193, v248
    v_sub_f32 v194, v194, v248
    v_sub_f32 v195, v195, v248
    v_sub_f32 v196, v196, v248
    v_sub_f32 v197, v197, v248
    v_sub_f32 v198, v198, v248
    v_sub_f32 v199, v199, v248
    v_sub_f32 v200, v200, v248
    v_sub_f32 v201, v201, v248
    v_sub_f32 v202, v202, v248
    v_sub_f32 v203, v203, v248
    v_sub_f32 v204, v204, v248
    v_sub_f32 v205, v205, v248
    v_sub_f32 v206, v206, v248
    v_sub_f32 v207, v207, v248
    v_exp_f32 v192, v192
    v_exp_f32 v193, v193
    v_exp_f32 v194, v194
    v_exp_f32 v195, v195
    v_exp_f32 v196, v196
    v_exp_f32 v197, v197
    v_exp_f32 v198, v198
    v_exp_f32 v199, v199
    v_exp_f32 v200, v200
    v_exp_f32 v201, v201
    v_exp_f32 v202, v202
    v_exp_f32 v203, v203
    v_exp_f32 v204, v204
    v_exp_f32 v205, v205
    v_exp_f32 v206, v206
    v_exp_f32 v207, v207
    s_nop 0
    v_cvt_pk_bf16_f32 v208, v192, v193
    v_cvt_pk_bf16_f32 v209, v194, v195
    v_cvt_pk_bf16_f32 v210, v196, v197
    v_cvt_pk_bf16_f32 v211, v198, v199
    v_cvt_pk_bf16_f32 v212, v200, v201
    v_cvt_pk_bf16_f32 v213, v202, v203
    v_cvt_pk_bf16_f32 v214, v204, v205
    v_cvt_pk_bf16_f32 v215, v206, v207
    s_nop 1
    v_mfma_f32_32x32x16_bf16 v[224:239], v[104:107], v[208:211], v[224:239]
    v_mfma_f32_32x32x16_bf16 v[224:239], v[108:111], v[212:215], v[224:239]
    v_mfma_f32_32x32x16_bf16 v[192:207], v[24:27], v[240:243], 0
    s_nop 11
    v_sub_f32 v192, v192, v248
    v_sub_f32 v193, v193, v248
    v_sub_f32 v194, v194, v248
    v_sub_f32 v195, v195, v248
    v_sub_f32 v196, v196, v248
    v_sub_f32 v197, v197, v248
    v_sub_f32 v198, v198, v248
    v_sub_f32 v199, v199, v248
    v_sub_f32 v200, v200, v248
    v_sub_f32 v201, v201, v248
    v_sub_f32 v202, v202, v248
    v_sub_f32 v203, v203, v248
    v_sub_f32 v204, v204, v248
    v_sub_f32 v205, v205, v248
    v_sub_f32 v206, v206, v248
    v_sub_f32 v207, v207, v248
    v_exp_f32 v192, v192
    v_exp_f32 v193, v193
    v_exp_f32 v194, v194
    v_exp_f32 v195, v195
    v_exp_f32 v196, v196
    v_exp_f32 v197, v197
    v_exp_f32 v198, v198
    v_exp_f32 v199, v199
    v_exp_f32 v200, v200
    v_exp_f32 v201, v201
    v_exp_f32 v202, v202
    v_exp_f32 v203, v203
    v_exp_f32 v204, v204
    v_exp_f32 v205, v205
    v_exp_f32 v206, v206
    v_exp_f32 v207, v207
    s_nop 0
    v_cvt_pk_bf16_f32 v208, v192, v193
    v_cvt_pk_bf16_f32 v209, v194, v195
    v_cvt_pk_bf16_f32 v210, v196, v197
    v_cvt_pk_bf16_f32 v211, v198, v199
    v_cvt_pk_bf16_f32 v212, v200, v201
    v_cvt_pk_bf16_f32 v213, v202, v203
    v_cvt_pk_bf16_f32 v214, v204, v205
    v_cvt_pk_bf16_f32 v215, v206, v207
    s_nop 1
    v_mfma_f32_32x32x16_bf16 v[224:239], v[112:115], v[208:211], v[224:239]
    v_mfma_f32_32x32x16_bf16 v[224:239], v[116:119], v[212:215], v[224:239]
    v_mfma_f32_32x32x16_bf16 v[192:207], v[28:31], v[240:243], 0
    s_nop 11
    v_sub_f32 v192, v192, v248
    v_sub_f32 v193, v193, v248
    v_sub_f32 v194, v194, v248
    v_sub_f32 v195, v195, v248
    v_sub_f32 v196, v196, v248
    v_sub_f32 v197, v197, v248
    v_sub_f32 v198, v198, v248
    v_sub_f32 v199, v199, v248
    v_sub_f32 v200, v200, v248
    v_sub_f32 v201, v201, v248
    v_sub_f32 v202, v202, v248
    v_sub_f32 v203, v203, v248
    v_sub_f32 v204, v204, v248
    v_sub_f32 v205, v205, v248
    v_sub_f32 v206, v206, v248
    v_sub_f32 v207, v207, v248
    v_exp_f32 v192, v192
    v_exp_f32 v193, v193
    v_exp_f32 v194, v194
    v_exp_f32 v195, v195
    v_exp_f32 v196, v196
    v_exp_f32 v197, v197
    v_exp_f32 v198, v198
    v_exp_f32 v199, v199
    v_exp_f32 v200, v200
    v_exp_f32 v201, v201
    v_exp_f32 v202, v202
    v_exp_f32 v203, v203
    v_exp_f32 v204, v204
    v_exp_f32 v205, v205
    v_exp_f32 v206, v206
    v_exp_f32 v207, v207
    s_nop 0
    v_cvt_pk_bf16_f32 v208, v192, v193
    v_cvt_pk_bf16_f32 v209, v194, v195
    v_cvt_pk_bf16_f32 v210, v196, v197
    v_cvt_pk_bf16_f32 v211, v198, v199
    v_cvt_pk_bf16_f32 v212, v200, v201
    v_cvt_pk_bf16_f32 v213, v202, v203
    v_cvt_pk_bf16_f32 v214, v204, v205
    v_cvt_pk_bf16_f32 v215, v206, v207
    s_nop 1
    v_mfma_f32_32x32x16_bf16 v[224:239], v[120:123], v[208:211], v[224:239]
    v_mfma_f32_32x32x16_bf16 v[224:239], v[124:127], v[212:215], v[224:239]
    v_mfma_f32_32x32x16_bf16 v[192:207], v[32:35], v[240:243], 0
    s_nop 11
    v_sub_f32 v192, v192, v248
    v_sub_f32 v193, v193, v248
    v_sub_f32 v194, v194, v248
    v_sub_f32 v195, v195, v248
    v_sub_f32 v196, v196, v248
    v_sub_f32 v197, v197, v248
    v_sub_f32 v198, v198, v248
    v_sub_f32 v199, v199, v248
    v_sub_f32 v200, v200, v248
    v_sub_f32 v201, v201, v248
    v_sub_f32 v202, v202, v248
    v_sub_f32 v203, v203, v248
    v_sub_f32 v204, v204, v248
    v_sub_f32 v205, v205, v248
    v_sub_f32 v206, v206, v248
    v_sub_f32 v207, v207, v248
    v_exp_f32 v192, v192
    v_exp_f32 v193, v193
    v_exp_f32 v194, v194
    v_exp_f32 v195, v195
    v_exp_f32 v196, v196
    v_exp_f32 v197, v197
    v_exp_f32 v198, v198
    v_exp_f32 v199, v199
    v_exp_f32 v200, v200
    v_exp_f32 v201, v201
    v_exp_f32 v202, v202
    v_exp_f32 v203, v203
    v_exp_f32 v204, v204
    v_exp_f32 v205, v205
    v_exp_f32 v206, v206
    v_exp_f32 v207, v207
    s_nop 0
    v_cvt_pk_bf16_f32 v208, v192, v193
    v_cvt_pk_bf16_f32 v209, v194, v195
    v_cvt_pk_bf16_f32 v210, v196, v197
    v_cvt_pk_bf16_f32 v211, v198, v199
    v_cvt_pk_bf16_f32 v212, v200, v201
    v_cvt_pk_bf16_f32 v213, v202, v203
    v_cvt_pk_bf16_f32 v214, v204, v205
    v_cvt_pk_bf16_f32 v215, v206, v207
    s_nop 1
    v_mfma_f32_32x32x16_bf16 v[224:239], v[128:131], v[208:211], v[224:239]
    v_mfma_f32_32x32x16_bf16 v[224:239], v[132:135], v[212:215], v[224:239]
    v_mfma_f32_32x32x16_bf16 v[192:207], v[36:39], v[240:243], 0
    s_nop 11
    v_sub_f32 v192, v192, v248
    v_sub_f32 v193, v193, v248
    v_sub_f32 v194, v194, v248
    v_sub_f32 v195, v195, v248
    v_sub_f32 v196, v196, v248
    v_sub_f32 v197, v197, v248
    v_sub_f32 v198, v198, v248
    v_sub_f32 v199, v199, v248
    v_sub_f32 v200, v200, v248
    v_sub_f32 v201, v201, v248
    v_sub_f32 v202, v202, v248
    v_sub_f32 v203, v203, v248
    v_sub_f32 v204, v204, v248
    v_sub_f32 v205, v205, v248
    v_sub_f32 v206, v206, v248
    v_sub_f32 v207, v207, v248
    v_exp_f32 v192, v192
    v_exp_f32 v193, v193
    v_exp_f32 v194, v194
    v_exp_f32 v195, v195
    v_exp_f32 v196, v196
    v_exp_f32 v197, v197
    v_exp_f32 v198, v198
    v_exp_f32 v199, v199
    v_exp_f32 v200, v200
    v_exp_f32 v201, v201
    v_exp_f32 v202, v202
    v_exp_f32 v203, v203
    v_exp_f32 v204, v204
    v_exp_f32 v205, v205
    v_exp_f32 v206, v206
    v_exp_f32 v207, v207
    s_nop 0
    v_cvt_pk_bf16_f32 v208, v192, v193
    v_cvt_pk_bf16_f32 v209, v194, v195
    v_cvt_pk_bf16_f32 v210, v196, v197
    v_cvt_pk_bf16_f32 v211, v198, v199
    v_cvt_pk_bf16_f32 v212, v200, v201
    v_cvt_pk_bf16_f32 v213, v202, v203
    v_cvt_pk_bf16_f32 v214, v204, v205
    v_cvt_pk_bf16_f32 v215, v206, v207
    s_nop 1
    v_mfma_f32_32x32x16_bf16 v[224:239], v[136:139], v[208:211], v[224:239]
    v_mfma_f32_32x32x16_bf16 v[224:239], v[140:143], v[212:215], v[224:239]
    v_mfma_f32_32x32x16_bf16 v[192:207], v[40:43], v[240:243], 0
    s_nop 11
    v_sub_f32 v192, v192, v248
    v_sub_f32 v193, v193, v248
    v_sub_f32 v194, v194, v248
    v_sub_f32 v195, v195, v248
    v_sub_f32 v196, v196, v248
    v_sub_f32 v197, v197, v248
    v_sub_f32 v198, v198, v248
    v_sub_f32 v199, v199, v248
    v_sub_f32 v200, v200, v248
    v_sub_f32 v201, v201, v248
    v_sub_f32 v202, v202, v248
    v_sub_f32 v203, v203, v248
    v_sub_f32 v204, v204, v248
    v_sub_f32 v205, v205, v248
    v_sub_f32 v206, v206, v248
    v_sub_f32 v207, v207, v248
    v_exp_f32 v192, v192
    v_exp_f32 v193, v193
    v_exp_f32 v194, v194
    v_exp_f32 v195, v195
    v_exp_f32 v196, v196
    v_exp_f32 v197, v197
    v_exp_f32 v198, v198
    v_exp_f32 v199, v199
    v_exp_f32 v200, v200
    v_exp_f32 v201, v201
    v_exp_f32 v202, v202
    v_exp_f32 v203, v203
    v_exp_f32 v204, v204
    v_exp_f32 v205, v205
    v_exp_f32 v206, v206
    v_exp_f32 v207, v207
    s_nop 0
    v_cvt_pk_bf16_f32 v208, v192, v193
    v_cvt_pk_bf16_f32 v209, v194, v195
    v_cvt_pk_bf16_f32 v210, v196, v197
    v_cvt_pk_bf16_f32 v211, v198, v199
    v_cvt_pk_bf16_f32 v212, v200, v201
    v_cvt_pk_bf16_f32 v213, v202, v203
    v_cvt_pk_bf16_f32 v214, v204, v205
    v_cvt_pk_bf16_f32 v215, v206, v207
    s_nop 1
    v_mfma_f32_32x32x16_bf16 v[224:239], v[144:147], v[208:211], v[224:239]
    v_mfma_f32_32x32x16_bf16 v[224:239], v[148:151], v[212:215], v[224:239]
    v_mfma_f32_32x32x16_bf16 v[192:207], v[44:47], v[240:243], 0
    s_nop 11
    v_sub_f32 v192, v192, v248
    v_sub_f32 v193, v193, v248
    v_sub_f32 v194, v194, v248
    v_sub_f32 v195, v195, v248
    v_sub_f32 v196, v196, v248
    v_sub_f32 v197, v197, v248
    v_sub_f32 v198, v198, v248
    v_sub_f32 v199, v199, v248
    v_sub_f32 v200, v200, v248
    v_sub_f32 v201, v201, v248
    v_sub_f32 v202, v202, v248
    v_sub_f32 v203, v203, v248
    v_sub_f32 v204, v204, v248
    v_sub_f32 v205, v205, v248
    v_sub_f32 v206, v206, v248
    v_sub_f32 v207, v207, v248
    v_exp_f32 v192, v192
    v_exp_f32 v193, v193
    v_exp_f32 v194, v194
    v_exp_f32 v195, v195
    v_exp_f32 v196, v196
    v_exp_f32 v197, v197
    v_exp_f32 v198, v198
    v_exp_f32 v199, v199
    v_exp_f32 v200, v200
    v_exp_f32 v201, v201
    v_exp_f32 v202, v202
    v_exp_f32 v203, v203
    v_exp_f32 v204, v204
    v_exp_f32 v205, v205
    v_exp_f32 v206, v206
    v_exp_f32 v207, v207
    s_nop 0
    v_cvt_pk_bf16_f32 v208, v192, v193
    v_cvt_pk_bf16_f32 v209, v194, v195
    v_cvt_pk_bf16_f32 v210, v196, v197
    v_cvt_pk_bf16_f32 v211, v198, v199
    v_cvt_pk_bf16_f32 v212, v200, v201
    v_cvt_pk_bf16_f32 v213, v202, v203
    v_cvt_pk_bf16_f32 v214, v204, v205
    v_cvt_pk_bf16_f32 v215, v206, v207
    s_nop 1
    v_mfma_f32_32x32x16_bf16 v[224:239], v[152:155], v[208:211], v[224:239]
    v_mfma_f32_32x32x16_bf16 v[224:239], v[156:159], v[212:215], v[224:239]
    v_mfma_f32_32x32x16_bf16 v[192:207], v[48:51], v[240:243], 0
    s_nop 11
    v_sub_f32 v192, v192, v248
    v_sub_f32 v193, v193, v248
    v_sub_f32 v194, v194, v248
    v_sub_f32 v195, v195, v248
    v_sub_f32 v196, v196, v248
    v_sub_f32 v197, v197, v248
    v_sub_f32 v198, v198, v248
    v_sub_f32 v199, v199, v248
    v_sub_f32 v200, v200, v248
    v_sub_f32 v201, v201, v248
    v_sub_f32 v202, v202, v248
    v_sub_f32 v203, v203, v248
    v_sub_f32 v204, v204, v248
    v_sub_f32 v205, v205, v248
    v_sub_f32 v206, v206, v248
    v_sub_f32 v207, v207, v248
    v_exp_f32 v192, v192
    v_exp_f32 v193, v193
    v_exp_f32 v194, v194
    v_exp_f32 v195, v195
    v_exp_f32 v196, v196
    v_exp_f32 v197, v197
    v_exp_f32 v198, v198
    v_exp_f32 v199, v199
    v_exp_f32 v200, v200
    v_exp_f32 v201, v201
    v_exp_f32 v202, v202
    v_exp_f32 v203, v203
    v_exp_f32 v204, v204
    v_exp_f32 v205, v205
    v_exp_f32 v206, v206
    v_exp_f32 v207, v207
    s_nop 0
    v_cvt_pk_bf16_f32 v208, v192, v193
    v_cvt_pk_bf16_f32 v209, v194, v195
    v_cvt_pk_bf16_f32 v210, v196, v197
    v_cvt_pk_bf16_f32 v211, v198, v199
    v_cvt_pk_bf16_f32 v212, v200, v201
    v_cvt_pk_bf16_f32 v213, v202, v203
    v_cvt_pk_bf16_f32 v214, v204, v205
    v_cvt_pk_bf16_f32 v215, v206, v207
    s_nop 1
    v_mfma_f32_32x32x16_bf16 v[224:239], v[160:163], v[208:211], v[224:239]
    v_mfma_f32_32x32x16_bf16 v[224:239], v[164:167], v[212:215], v[224:239]
    v_mfma_f32_32x32x16_bf16 v[192:207], v[52:55], v[240:243], 0
    s_nop 11
    v_sub_f32 v192, v192, v248
    v_sub_f32 v193, v193, v248
    v_sub_f32 v194, v194, v248
    v_sub_f32 v195, v195, v248
    v_sub_f32 v196, v196, v248
    v_sub_f32 v197, v197, v248
    v_sub_f32 v198, v198, v248
    v_sub_f32 v199, v199, v248
    v_sub_f32 v200, v200, v248
    v_sub_f32 v201, v201, v248
    v_sub_f32 v202, v202, v248
    v_sub_f32 v203, v203, v248
    v_sub_f32 v204, v204, v248
    v_sub_f32 v205, v205, v248
    v_sub_f32 v206, v206, v248
    v_sub_f32 v207, v207, v248
    v_exp_f32 v192, v192
    v_exp_f32 v193, v193
    v_exp_f32 v194, v194
    v_exp_f32 v195, v195
    v_exp_f32 v196, v196
    v_exp_f32 v197, v197
    v_exp_f32 v198, v198
    v_exp_f32 v199, v199
    v_exp_f32 v200, v200
    v_exp_f32 v201, v201
    v_exp_f32 v202, v202
    v_exp_f32 v203, v203
    v_exp_f32 v204, v204
    v_exp_f32 v205, v205
    v_exp_f32 v206, v206
    v_exp_f32 v207, v207
    s_nop 0
    v_cvt_pk_bf16_f32 v208, v192, v193
    v_cvt_pk_bf16_f32 v209, v194, v195
    v_cvt_pk_bf16_f32 v210, v196, v197
    v_cvt_pk_bf16_f32 v211, v198, v199
    v_cvt_pk_bf16_f32 v212, v200, v201
    v_cvt_pk_bf16_f32 v213, v202, v203
    v_cvt_pk_bf16_f32 v214, v204, v205
    v_cvt_pk_bf16_f32 v215, v206, v207
    s_nop 1
    v_mfma_f32_32x32x16_bf16 v[224:239], v[168:171], v[208:211], v[224:239]
    v_mfma_f32_32x32x16_bf16 v[224:239], v[172:175], v[212:215], v[224:239]
    v_mfma_f32_32x32x16_bf16 v[192:207], v[56:59], v[240:243], 0
    s_nop 11
    v_sub_f32 v192, v192, v248
    v_sub_f32 v193, v193, v248
    v_sub_f32 v194, v194, v248
    v_sub_f32 v195, v195, v248
    v_sub_f32 v196, v196, v248
    v_sub_f32 v197, v197, v248
    v_sub_f32 v198, v198, v248
    v_sub_f32 v199, v199, v248
    v_sub_f32 v200, v200, v248
    v_sub_f32 v201, v201, v248
    v_sub_f32 v202, v202, v248
    v_sub_f32 v203, v203, v248
    v_sub_f32 v204, v204, v248
    v_sub_f32 v205, v205, v248
    v_sub_f32 v206, v206, v248
    v_sub_f32 v207, v207, v248
    v_exp_f32 v192, v192
    v_exp_f32 v193, v193
    v_exp_f32 v194, v194
    v_exp_f32 v195, v195
    v_exp_f32 v196, v196
    v_exp_f32 v197, v197
    v_exp_f32 v198, v198
    v_exp_f32 v199, v199
    v_exp_f32 v200, v200
    v_exp_f32 v201, v201
    v_exp_f32 v202, v202
    v_exp_f32 v203, v203
    v_exp_f32 v204, v204
    v_exp_f32 v205, v205
    v_exp_f32 v206, v206
    v_exp_f32 v207, v207
    s_nop 0
    v_cvt_pk_bf16_f32 v208, v192, v193
    v_cvt_pk_bf16_f32 v209, v194, v195
    v_cvt_pk_bf16_f32 v210, v196, v197
    v_cvt_pk_bf16_f32 v211, v198, v199
    v_cvt_pk_bf16_f32 v212, v200, v201
    v_cvt_pk_bf16_f32 v213, v202, v203
    v_cvt_pk_bf16_f32 v214, v204, v205
    v_cvt_pk_bf16_f32 v215, v206, v207
    s_nop 1
    v_mfma_f32_32x32x16_bf16 v[224:239], v[176:179], v[208:211], v[224:239]
    v_mfma_f32_32x32x16_bf16 v[224:239], v[180:183], v[212:215], v[224:239]
    v_mfma_f32_32x32x16_bf16 v[192:207], v[60:63], v[240:243], 0
    s_nop 11
    v_sub_f32 v192, v192, v248
    v_sub_f32 v193, v193, v248
    v_sub_f32 v194, v194, v248
    v_sub_f32 v195, v195, v248
    v_sub_f32 v196, v196, v248
    v_sub_f32 v197, v197, v248
    v_sub_f32 v198, v198, v248
    v_sub_f32 v199, v199, v248
    v_sub_f32 v200, v200, v248
    v_sub_f32 v201, v201, v248
    v_sub_f32 v202, v202, v248
    v_sub_f32 v203, v203, v248
    v_sub_f32 v204, v204, v248
    v_sub_f32 v205, v205, v248
    v_sub_f32 v206, v206, v248
    v_sub_f32 v207, v207, v248
    v_exp_f32 v192, v192
    v_exp_f32 v193, v193
    v_exp_f32 v194, v194
    v_exp_f32 v195, v195
    v_exp_f32 v196, v196
    v_exp_f32 v197, v197
    v_exp_f32 v198, v198
    v_exp_f32 v199, v199
    v_exp_f32 v200, v200
    v_exp_f32 v201, v201
    v_exp_f32 v202, v202
    v_exp_f32 v203, v203
    v_exp_f32 v204, v204
    v_exp_f32 v205, v205
    v_exp_f32 v206, v206
    v_exp_f32 v207, v207
    s_nop 0
    v_cvt_pk_bf16_f32 v208, v192, v193
    v_cvt_pk_bf16_f32 v209, v194, v195
    v_cvt_pk_bf16_f32 v210, v196, v197
    v_cvt_pk_bf16_f32 v211, v198, v199
    v_cvt_pk_bf16_f32 v212, v200, v201
    v_cvt_pk_bf16_f32 v213, v202, v203
    v_cvt_pk_bf16_f32 v214, v204, v205
    v_cvt_pk_bf16_f32 v215, v206, v207
    s_nop 1
    v_mfma_f32_32x32x16_bf16 v[224:239], v[184:187], v[208:211], v[224:239]
    v_mfma_f32_32x32x16_bf16 v[224:239], v[188:191], v[212:215], v[224:239]
    s_cmp_lg_u32 s62, 6
    s_cbranch_scc1 L_slow5
    s_mov_b32 s63, 0
    v_mov_b32 v249, 160028
L_slow4:
    ds_read_b32 v248, v249
    s_add_u32 s63, s63, 1
    s_cmp_gt_u32 s63, 1000000
    s_cbranch_scc1 L_slow4x
    s_waitcnt lgkmcnt(0)
    v_cmp_ne_u32 vcc, 4, v248
    s_cbranch_vccnz L_slow4
L_slow4x:
    v_subrev_u32 v244, 151552, v244
L_slow5:
    s_cmp_eq_u32 s62, 1
    s_cbranch_scc1 L_last
    s_nop 11
    ds_write2st64_b32 v244, v224, v225 offset0:0 offset1:4
    ds_write2st64_b32 v244, v226, v227 offset0:8 offset1:12
    ds_write2st64_b32 v244, v228, v229 offset0:16 offset1:20
    ds_write2st64_b32 v244, v230, v231 offset0:24 offset1:28
    ds_write2st64_b32 v244, v232, v245 offset0:32 offset1:36
    v_add_u32 v244, 10240, v244
    s_sub_u32 s62, s62, 1
    s_branch L_slow
L_Gjoin:
    s_sub_u32 s50, s50, 4
    ds_read_b32 v178, v177 offset:2800
    ds_read_u16 v152, v12
    ds_read_u16 v156, v12 offset:64
    ds_read_u16 v168, v13
    ds_read_u16 v172, v13 offset:64
    s_setprio 3
    s_waitcnt lgkmcnt(0)
    v_readfirstlane_b32 s53, v178
    s_nop 3
    s_setprio 0
    s_lshl_b32 s64, s51, 8
    s_add_u32 s64, s64, 4096
    s_mul_i32 s4, s50, 458752
    s_lshl_b32 s55, s52, 7
    s_add_u32 s4, s4, s55
    s_lshl_b32 s7, s50, 17
    s_add_u32 s7, s7, s55
    s_mul_i32 s5, s51, 229376
    s_add_u32 s5, s5, 4194304
    s_lshl_b32 s24, s48, 11
    s_add_u32 s24, s24, s5
    s_add_u32 s25, s24, 114688
    s_mul_i32 s61, s50, 28672
    s_add_u32 s5, s5, s61
    s_and_b32 s6, s51, 3
    s_lshl_b32 s10, s51, 3
    s_add_u32 s8, s10, s52
    s_lshl_b32 s26, s8, 2
    s_add_u32 s26, s26, s50
    s_lshl_b32 s26, s26, 5
    s_add_u32 s26, s26, 65536
    s_lshl_b32 s8, s8, 3
    s_add_u32 s8, s8, s50
    s_lshl_b32 s8, s8, 10
    s_add_u32 s8, s8, 1048576
    s_add_u32 s9, s8, 4096
    s_lshl_b32 s60, s50, 1
    s_add_u32 s10, s10, s60
    s_lshl_b32 s27, s10, 7
    s_add_u32 s27, s27, 65536
    s_lshl_b32 s10, s10, 13
    s_add_u32 s10, s10, 1048576
    s_add_u32 s65, s10, 8192
    s_lshl_b32 s33, s51, 16
    s_add_u32 s11, s33, 1055744
    s_add_u32 s33, s33, s55
    s_add_u32 s34, s33, 0x8000
    s_lshl_b32 s60, s50, 13
    s_add_u32 s33, s33, s60
    s_movk_i32 s32, 10240
    s_cmp_lt_u32 s50, 2
    s_cselect_b32 s32, 4294939648, s32
    s_lshl_b32 s32, s32, 2
    s_cmp_eq_u32 s50, 3
    s_cbranch_scc1 L_F1w3
    s_add_u32 m0, s49, 0
    s_nop 0
    buffer_load_dwordx4 v148, s[20:23], s54 offen lds
    buffer_load_dwordx4 v149, s[20:23], s54 offen offset:1024 lds
    s_add_u32 s54, s54, 57344
    s_add_u32 m0, s49, 2048
    s_nop 0
    buffer_load_dwordx4 v148, s[20:23], s54 offen lds
    buffer_load_dwordx4 v149, s[20:23], s54 offen offset:1024 lds
    s_add_u32 s54, s54, 57344
    s_add_u32 m0, s49, 4096
    s_nop 0
    buffer_load_dwordx4 v148, s[20:23], s54 offen lds
    buffer_load_dwordx4 v149, s[20:23], s54 offen offset:1024 lds
    s_add_u32 s54, s54, 57344
    s_add_u32 m0, s49, 6144
    s_nop 0
    buffer_load_dwordx4 v148, s[20:23], s54 offen lds
    buffer_load_dwordx4 v149, s[20:23], s54 offen offset:1024 lds
    s_add_u32 s54, s54, 57344
    s_add_u32 m0, s49, 8192
    s_nop 0
    buffer_load_dwordx4 v148, s[20:23], s54 offen lds
    buffer_load_dwordx4 v149, s[20:23], s54 offen offset:1024 lds
    s_add_u32 s54, s54, 57344
    s_add_u32 m0, s49, 10240
    s_nop 0
    buffer_load_dwordx4 v148, s[20:23], s54 offen lds
    buffer_load_dwordx4 v149, s[20:23], s54 offen offset:1024 lds
    s_add_u32 s54, s54, 57344
    s_add_u32 m0, s49, 12288
    s_nop 0
    buffer_load_dwordx4 v148, s[20:23], s54 offen lds
    buffer_load_dwordx4 v149, s[20:23], s54 offen offset:1024 lds
    s_add_u32 s54, s54, 57344
    s_add_u32 m0, s49, 14336
    s_nop 0
    buffer_load_dwordx4 v148, s[20:23], s54 offen lds
    buffer_load_dwordx4 v149, s[20:23], s54 offen offset:1024 lds
    s_add_u32 s55, s3, 1
    s_and_b32 s55, s55, 3
    s_mul_i32 s55, s55, 458752
    s_add_u32 s54, s100, s55
    s_waitcnt vmcnt(14)
    ds_read_b64_tr_b16 v[120:121], v144 offset:0
    ds_read_b64_tr_b16 v[122:123], v144 offset:512
    ds_read_b128 v[64:67], v136 offset:0
    ds_read_b64_tr_b16 v[124:125], v145 offset:0
    ds_read_b64_tr_b16 v[126:127], v145 offset:512
    ds_read_b128 v[68:71], v136 offset:8192
    v_mfma_f32_32x32x16_bf16 v[0:15], v[152:155], v[160:163], 0
    v_mfma_f32_32x32x16_bf16 v[16:31], v[156:159], v[160:163], 0
    v_mfma_f32_32x32x16_bf16 v[32:47], v[152:155], v[160:163], 0
    v_mfma_f32_32x32x16_bf16 v[48:63], v[156:159], v[160:163], 0
    s_waitcnt vmcnt(12) lgkmcnt(0)
    v_mfma_f32_32x32x16_bf16 v[0:15], v[120:123], v[64:67], v[0:15]
    ds_read_b64_tr_b16 v[128:129], v144 offset:2048
    ds_read_b64_tr_b16 v[130:131], v144 offset:2560
    ds_read_b128 v[72:75], v137 offset:0
    v_mfma_f32_32x32x16_bf16 v[16:31], v[124:127], v[64:67], v[16:31]
    ds_read_b64_tr_b16 v[132:133], v145 offset:2048
    ds_read_b64_tr_b16 v[134:135], v145 offset:2560
    ds_read_b128 v[76:79], v137 offset:8192
    v_mfma_f32_32x32x16_bf16 v[32:47], v[120:123], v[68:71], v[32:47]
    v_mfma_f32_32x32x16_bf16 v[48:63], v[124:127], v[68:71], v[48:63]
    s_waitcnt vmcnt(10) lgkmcnt(0)
    v_mfma_f32_32x32x16_bf16 v[0:15], v[128:131], v[72:75], v[0:15]
    ds_read_b64_tr_b16 v[120:121], v144 offset:4096
    ds_read_b64_tr_b16 v[122:123], v144 offset:4608
    ds_read_b128 v[64:67], v138 offset:0
    v_mfma_f32_32x32x16_bf16 v[16:31], v[132:135], v[72:75], v[16:31]
    ds_read_b64_tr_b16 v[124:125], v145 offset:4096
    ds_read_b64_tr_b16 v[126:127], v145 offset:4608
    ds_read_b128 v[68:71], v138 offset:8192
    v_mfma_f32_32x32x16_bf16 v[32:47], v[128:131], v[76:79], v[32:47]
    v_mfma_f32_32x32x16_bf16 v[48:63], v[132:135], v[76:79], v[48:63]
    s_waitcnt vmcnt(8) lgkmcnt(0)
    v_mfma_f32_32x32x16_bf16 v[0:15], v[120:123], v[64:67], v[0:15]
    ds_read_b64_tr_b16 v[128:129], v144 offset:6144
    ds_read_b64_tr_b16 v[130:131], v144 offset:6656
    ds_read_b128 v[72:75], v139 offset:0
    v_mfma_f32_32x32x16_bf16 v[16:31], v[124:127], v[64:67], v[16:31]
    ds_read_b64_tr_b16 v[132:133], v145 offset:6144
    ds_read_b64_tr_b16 v[134:135], v145 offset:6656
    ds_read_b128 v[76:79], v139 offset:8192
    v_mfma_f32_32x32x16_bf16 v[32:47], v[120:123], v[68:71], v[32:47]
    v_mfma_f32_32x32x16_bf16 v[48:63], v[124:127], v[68:71], v[48:63]
    s_waitcnt vmcnt(6) lgkmcnt(0)
    v_mfma_f32_32x32x16_bf16 v[0:15], v[128:131], v[72:75], v[0:15]
    ds_read_b64_tr_b16 v[120:121], v144 offset:8192
    ds_read_b64_tr_b16 v[122:123], v144 offset:8704
    ds_read_b128 v[64:67], v140 offset:0
    v_mfma_f32_32x32x16_bf16 v[16:31], v[132:135], v[72:75], v[16:31]
    ds_read_b64_tr_b16 v[124:125], v145 offset:8192
    ds_read_b64_tr_b16 v[126:127], v145 offset:8704
    ds_read_b128 v[68:71], v140 offset:8192
    v_mfma_f32_32x32x16_bf16 v[32:47], v[128:131], v[76:79], v[32:47]
    v_mfma_f32_32x32x16_bf16 v[48:63], v[132:135], v[76:79], v[48:63]
    s_waitcnt vmcnt(4) lgkmcnt(0)
    v_mfma_f32_32x32x16_bf16 v[0:15], v[120:123], v[64:67], v[0:15]
    ds_read_b64_tr_b16 v[128:129], v144 offset:10240
    ds_read_b64_tr_b16 v[130:131], v144 offset:10752
    ds_read_b128 v[72:75], v141 offset:0
    v_mfma_f32_32x32x16_bf16 v[16:31], v[124:127], v[64:67], v[16:31]
    ds_read_b64_tr_b16 v[132:133], v145 offset:10240
    ds_read_b64_tr_b16 v[134:135], v145 offset:10752
    ds_read_b128 v[76:79], v141 offset:8192
    v_mfma_f32_32x32x16_bf16 v[32:47], v[120:123], v[68:71], v[32:47]
    v_mfma_f32_32x32x16_bf16 v[48:63], v[124:127], v[68:71], v[48:63]
    s_waitcnt vmcnt(2) lgkmcnt(0)
    v_mfma_f32_32x32x16_bf16 v[0:15], v[128:131], v[72:75], v[0:15]
    ds_read_b64_tr_b16 v[120:121], v144 offset:12288
    ds_read_b64_tr_b16 v[122:123], v144 offset:12800
    ds_read_b128 v[64:67], v142 offset:0
    v_mfma_f32_32x32x16_bf16 v[16:31], v[132:135], v[72:75], v[16:31]
    ds_read_b64_tr_b16 v[124:125], v145 offset:12288
    ds_read_b64_tr_b16 v[126:127], v145 offset:12800
    ds_read_b128 v[68:71], v142 offset:8192
    v_mfma_f32_32x32x16_bf16 v[32:47], v[128:131], v[76:79], v[32:47]
    v_mfma_f32_32x32x16_bf16 v[48:63], v[132:135], v[76:79], v[48:63]
    s_waitcnt vmcnt(0) lgkmcnt(0)
    v_mfma_f32_32x32x16_bf16 v[0:15], v[120:123], v[64:67], v[0:15]
    ds_read_b64_tr_b16 v[128:129], v144 offset:14336
    ds_read_b64_tr_b16 v[130:131], v144 offset:14848
    ds_read_b128 v[72:75], v143 offset:0
    v_mfma_f32_32x32x16_bf16 v[16:31], v[124:127], v[64:67], v[16:31]
    ds_read_b64_tr_b16 v[132:133], v145 offset:14336
    ds_read_b64_tr_b16 v[134:135], v145 offset:14848
    ds_read_b128 v[76:79], v143 offset:8192
    v_mfma_f32_32x32x16_bf16 v[32:47], v[120:123], v[68:71], v[32:47]
    v_mfma_f32_32x32x16_bf16 v[48:63], v[124:127], v[68:71], v[48:63]
    s_waitcnt vmcnt(63) lgkmcnt(0)
    v_mfma_f32_32x32x16_bf16 v[0:15], v[128:131], v[72:75], v[0:15]
    v_mfma_f32_32x32x16_bf16 v[16:31], v[132:135], v[72:75], v[16:31]
    v_mfma_f32_32x32x16_bf16 v[32:47], v[128:131], v[76:79], v[32:47]
    s_mov_b64 exec, 1
    ds_add_u32 v177, v167 offset:0
    s_mov_b64 exec, -1
    v_mfma_f32_32x32x16_bf16 v[48:63], v[132:135], v[76:79], v[48:63]
    s_setprio 3
    s_mov_b32 s63, 0
L_goa:
    ds_read_b32 v178, v177 offset:84
    s_add_u32 s63, s63, 1
    s_cmp_gt_u32 s63, 1000000
    s_cbranch_scc1 L_goa_x
    s_waitcnt lgkmcnt(0)
    v_cmp_ne_u32 vcc, s53, v178
    s_cbranch_vccz L_goa_x
    s_sleep 2
    s_branch L_goa
L_goa_x:
    s_setprio 0
    s_add_u32 m0, s49, 0
    s_nop 0
    buffer_load_dwordx4 v148, s[20:23], s54 offen lds
    buffer_load_dwordx4 v149, s[20:23], s54 offen offset:1024 lds
    s_add_u32 s54, s54, 57344
    s_add_u32 m0, s49, 2048
    s_nop 0
    buffer_load_dwordx4 v148, s[20:23], s54 offen lds
    buffer_load_dwordx4 v149, s[20:23], s54 offen offset:1024 lds
    s_add_u32 s54, s54, 57344
    s_add_u32 m0, s49, 4096
    s_nop 0
    buffer_load_dwordx4 v148, s[20:23], s54 offen lds
    buffer_load_dwordx4 v149, s[20:23], s54 offen offset:1024 lds
    s_add_u32 s54, s54, 57344
    s_add_u32 m0, s49, 6144
    s_nop 0
    buffer_load_dwordx4 v148, s[20:23], s54 offen lds
    buffer_load_dwordx4 v149, s[20:23], s54 offen offset:1024 lds
    s_add_u32 s54, s54, 57344
    s_add_u32 m0, s49, 8192
    s_nop 0
    buffer_load_dwordx4 v148, s[20:23], s54 offen lds
    buffer_load_dwordx4 v149, s[20:23], s54 offen offset:1024 lds
    s_add_u32 s54, s54, 57344
    s_add_u32 m0, s49, 10240
    s_nop 0
    buffer_load_dwordx4 v148, s[20:23], s54 offen lds
    buffer_load_dwordx4 v149, s[20:23], s54 offen offset:1024 lds
    s_add_u32 s54, s54, 57344
    s_add_u32 m0, s49, 12288
    s_nop 0
    buffer_load_dwordx4 v148, s[20:23], s54 offen lds
    buffer_load_dwordx4 v149, s[20:23], s54 offen offset:1024 lds
    s_add_u32 s54, s54, 57344
    s_add_u32 m0, s49, 14336
    s_nop 0
    buffer_load_dwordx4 v148, s[20:23], s54 offen lds
    buffer_load_dwordx4 v149, s[20:23], s54 offen offset:1024 lds
    s_add_u32 s55, s3, 2
    s_and_b32 s55, s55, 3
    s_mul_i32 s55, s55, 458752
    s_add_u32 s54, s100, s55
    s_waitcnt vmcnt(14)
    ds_read_b64_tr_b16 v[120:121], v144 offset:0
    ds_read_b64_tr_b16 v[122:123], v144 offset:512
    ds_read_b128 v[64:67], v136 offset:16384
    ds_read_b64_tr_b16 v[124:125], v145 offset:0
    ds_read_b64_tr_b16 v[126:127], v145 offset:512
    ds_read_b128 v[68:71], v136 offset:24576
    s_waitcnt vmcnt(12) lgkmcnt(0)
    v_mfma_f32_32x32x16_bf16 v[0:15], v[120:123], v[64:67], v[0:15]
    ds_read_b64_tr_b16 v[128:129], v144 offset:2048
    ds_read_b64_tr_b16 v[130:131], v144 offset:2560
    ds_read_b128 v[72:75], v137 offset:16384
    v_mfma_f32_32x32x16_bf16 v[16:31], v[124:127], v[64:67], v[16:31]
    ds_read_b64_tr_b16 v[132:133], v145 offset:2048
    ds_read_b64_tr_b16 v[134:135], v145 offset:2560
    ds_read_b128 v[76:79], v137 offset:24576
    s_add_u32 m0, s49, 0
    v_mfma_f32_32x32x16_bf16 v[32:47], v[120:123], v[68:71], v[32:47]
    buffer_load_dwordx4 v148, s[20:23], s54 offen lds
    v_mfma_f32_32x32x16_bf16 v[48:63], v[124:127], v[68:71], v[48:63]
    buffer_load_dwordx4 v149, s[20:23], s54 offen offset:1024 lds
    s_add_u32 s54, s54, 57344
    s_waitcnt vmcnt(12) lgkmcnt(0)
    v_mfma_f32_32x32x16_bf16 v[0:15], v[128:131], v[72:75], v[0:15]
    ds_read_b64_tr_b16 v[120:121], v144 offset:4096
    ds_read_b64_tr_b16 v[122:123], v144 offset:4608
    ds_read_b128 v[64:67], v138 offset:16384
    v_mfma_f32_32x32x16_bf16 v[16:31], v[132:135], v[72:75], v[16:31]
    ds_read_b64_tr_b16 v[124:125], v145 offset:4096
    ds_read_b64_tr_b16 v[126:127], v145 offset:4608
    ds_read_b128 v[68:71], v138 offset:24576
    s_add_u32 m0, s49, 2048
    v_mfma_f32_32x32x16_bf16 v[32:47], v[128:131], v[76:79], v[32:47]
    buffer_load_dwordx4 v148, s[20:23], s54 offen lds
    v_mfma_f32_32x32x16_bf16 v[48:63], v[132:135], v[76:79], v[48:63]
    buffer_load_dwordx4 v149, s[20:23], s54 offen offset:1024 lds
    s_add_u32 s54, s54, 57344
    s_waitcnt vmcnt(12) lgkmcnt(0)
    v_mfma_f32_32x32x16_bf16 v[0:15], v[120:123], v[64:67], v[0:15]
    ds_read_b64_tr_b16 v[128:129], v144 offset:6144
    ds_read_b64_tr_b16 v[130:131], v144 offset:6656
    ds_read_b128 v[72:75], v139 offset:16384
    v_mfma_f32_32x32x16_bf16 v[16:31], v[124:127], v[64:67], v[16:31]
    ds_read_b64_tr_b16 v[132:133], v145 offset:6144
    ds_read_b64_tr_b16 v[134:135], v145 offset:6656
    ds_read_b128 v[76:79], v139 offset:24576
    s_add_u32 m0, s49, 4096
    v_mfma_f32_32x32x16_bf16 v[32:47], v[120:123], v[68:71], v[32:47]
    buffer_load_dwordx4 v148, s[20:23], s54 offen lds
    v_mfma_f32_32x32x16_bf16 v[48:63], v[124:127], v[68:71], v[48:63]
    buffer_load_dwordx4 v149, s[20:23], s54 offen offset:1024 lds
    s_add_u32 s54, s54, 57344
    s_waitcnt vmcnt(12) lgkmcnt(0)
    v_mfma_f32_32x32x16_bf16 v[0:15], v[128:131], v[72:75], v[0:15]
    ds_read_b64_tr_b16 v[120:121], v144 offset:8192
    ds_read_b64_tr_b16 v[122:123], v144 offset:8704
    ds_read_b128 v[64:67], v140 offset:16384
    v_mfma_f32_32x32x16_bf16 v[16:31], v[132:135], v[72:75], v[16:31]
    ds_read_b64_tr_b16 v[124:125], v145 offset:8192
    ds_read_b64_tr_b16 v[126:127], v145 offset:8704
    ds_read_b128 v[68:71], v140 offset:24576
    s_add_u32 m0, s49, 6144
    v_mfma_f32_32x32x16_bf16 v[32:47], v[128:131], v[76:79], v[32:47]
    buffer_load_dwordx4 v148, s[20:23], s54 offen lds
    v_mfma_f32_32x32x16_bf16 v[48:63], v[132:135], v[76:79], v[48:63]
    buffer_load_dwordx4 v149, s[20:23], s54 offen offset:1024 lds
    s_add_u32 s54, s54, 57344
    buffer_store_dwordx4 v[200:203], v166, s[44:47], s8 offen sc1
    buffer_store_dwordx4 v[200:203], v166, s[44:47], s9 offen sc1
    buffer_load_dword v178, v180, s[44:47], s27 offen sc1
    buffer_load_dwordx2 v[194:195], v180, s[44:47], s64 offen sc1
    s_cmp_eq_u32 s50, 0
    s_cbranch_scc0 L_f1m
    s_mul_i32 s60, s2, 7168
    s_lshr_b64 exec, -1, 8
    buffer_load_dword v178, v196, s[28:31], s60 offen
    s_mov_b64 exec, 0xffff
    s_lshl_b32 s60, s2, 11
    buffer_load_dword v178, v196, s[16:19], s60 offen
    s_mov_b64 exec, -1
L_f1m:
    s_waitcnt vmcnt(16) lgkmcnt(0)
    v_mfma_f32_32x32x16_bf16 v[0:15], v[120:123], v[64:67], v[0:15]
    ds_read_b64_tr_b16 v[128:129], v144 offset:10240
    ds_read_b64_tr_b16 v[130:131], v144 offset:10752
    ds_read_b128 v[72:75], v141 offset:16384
    v_mfma_f32_32x32x16_bf16 v[16:31], v[124:127], v[64:67], v[16:31]
    ds_read_b64_tr_b16 v[132:133], v145 offset:10240
    ds_read_b64_tr_b16 v[134:135], v145 offset:10752
    ds_read_b128 v[76:79], v141 offset:24576
    s_add_u32 m0, s49, 8192
    v_mfma_f32_32x32x16_bf16 v[32:47], v[120:123], v[68:71], v[32:47]
    buffer_load_dwordx4 v148, s[20:23], s54 offen lds
    v_mfma_f32_32x32x16_bf16 v[48:63], v[124:127], v[68:71], v[48:63]
    buffer_load_dwordx4 v149, s[20:23], s54 offen offset:1024 lds
    s_add_u32 s54, s54, 57344
    s_waitcnt vmcnt(16) lgkmcnt(0)
    v_mfma_f32_32x32x16_bf16 v[0:15], v[128:131], v[72:75], v[0:15]
    ds_read_b64_tr_b16 v[120:121], v144 offset:12288
    ds_read_b64_tr_b16 v[122:123], v144 offset:12800
    ds_read_b128 v[64:67], v142 offset:16384
    v_mfma_f32_32x32x16_bf16 v[16:31], v[132:135], v[72:75], v[16:31]
    ds_read_b64_tr_b16 v[124:125], v145 offset:12288
    ds_read_b64_tr_b16 v[126:127], v145 offset:12800
    ds_read_b128 v[68:71], v142 offset:24576
    s_add_u32 m0, s49, 10240
    v_mfma_f32_32x32x16_bf16 v[32:47], v[128:131], v[76:79], v[32:47]
    buffer_load_dwordx4 v148, s[20:23], s54 offen lds
    v_mfma_f32_32x32x16_bf16 v[48:63], v[132:135], v[76:79], v[48:63]
    buffer_load_dwordx4 v149, s[20:23], s54 offen offset:1024 lds
    s_add_u32 s54, s54, 57344
    s_waitcnt vmcnt(16) lgkmcnt(0)
    v_mfma_f32_32x32x16_bf16 v[0:15], v[120:123], v[64:67], v[0:15]
    ds_read_b64_tr_b16 v[128:129], v144 offset:14336
    ds_read_b64_tr_b16 v[130:131], v144 offset:14848
    ds_read_b128 v[72:75], v143 offset:16384
    v_mfma_f32_32x32x16_bf16 v[16:31], v[124:127], v[64:67], v[16:31]
    ds_read_b64_tr_b16 v[132:133], v145 offset:14336
    ds_read_b64_tr_b16 v[134:135], v145 offset:14848
    ds_read_b128 v[76:79], v143 offset:24576
    s_add_u32 m0, s49, 12288
    v_mfma_f32_32x32x16_bf16 v[32:47], v[120:123], v[68:71], v[32:47]
    buffer_load_dwordx4 v148, s[20:23], s54 offen lds
    v_mfma_f32_32x32x16_bf16 v[48:63], v[124:127], v[68:71], v[48:63]
    buffer_load_dwordx4 v149, s[20:23], s54 offen offset:1024 lds
    s_add_u32 s54, s54, 57344
    s_waitcnt vmcnt(16) lgkmcnt(0)
    v_mfma_f32_32x32x16_bf16 v[0:15], v[128:131], v[72:75], v[0:15]
    ds_read_b64_tr_b16 v[120:121], v144 offset:0
    ds_read_b64_tr_b16 v[122:123], v144 offset:512
    ds_read_b128 v[64:67], v136 offset:32768
    v_mfma_f32_32x32x16_bf16 v[16:31], v[132:135], v[72:75], v[16:31]
    ds_read_b64_tr_b16 v[124:125], v145 offset:0
    ds_read_b64_tr_b16 v[126:127], v145 offset:512
    ds_read_b128 v[68:71], v136 offset:40960
    s_add_u32 m0, s49, 14336
    v_mfma_f32_32x32x16_bf16 v[32:47], v[128:131], v[76:79], v[32:47]
    buffer_load_dwordx4 v148, s[20:23], s54 offen lds
    s_mov_b64 exec, 1
    ds_add_u32 v177, v167 offset:4
    s_mov_b64 exec, -1
    v_mfma_f32_32x32x16_bf16 v[48:63], v[132:135], v[76:79], v[48:63]
    buffer_load_dwordx4 v149, s[20:23], s54 offen offset:1024 lds
    s_add_u32 s55, s3, 3
    s_and_b32 s55, s55, 3
    s_mul_i32 s55, s55, 458752
    s_add_u32 s54, s100, s55
    s_waitcnt vmcnt(16) lgkmcnt(0)
    v_mfma_f32_32x32x16_bf16 v[0:15], v[120:123], v[64:67], v[0:15]
    ds_read_b64_tr_b16 v[128:129], v144 offset:2048
    ds_read_b64_tr_b16 v[130:131], v144 offset:2560
    ds_read_b128 v[72:75], v137 offset:32768
    v_mfma_f32_32x32x16_bf16 v[16:31], v[124:127], v[64:67], v[16:31]
    ds_read_b64_tr_b16 v[132:133], v145 offset:2048
    ds_read_b64_tr_b16 v[134:135], v145 offset:2560
    ds_read_b128 v[76:79], v137 offset:40960
    s_add_u32 m0, s49, 0
    v_mfma_f32_32x32x16_bf16 v[32:47], v[120:123], v[68:71], v[32:47]
    buffer_load_dwordx4 v148, s[20:23], s54 offen lds
    v_mfma_f32_32x32x16_bf16 v[48:63], v[124:127], v[68:71], v[48:63]
    buffer_load_dwordx4 v149, s[20:23], s54 offen offset:1024 lds
    s_add_u32 s54, s54, 57344
    s_waitcnt vmcnt(16) lgkmcnt(0)
    v_mfma_f32_32x32x16_bf16 v[0:15], v[128:131], v[72:75], v[0:15]
    ds_read_b64_tr_b16 v[120:121], v144 offset:4096
    ds_read_b64_tr_b16 v[122:123], v144 offset:4608
    ds_read_b128 v[64:67], v138 offset:32768
    v_mfma_f32_32x32x16_bf16 v[16:31], v[132:135], v[72:75], v[16:31]
    ds_read_b64_tr_b16 v[124:125], v145 offset:4096
    ds_read_b64_tr_b16 v[126:127], v145 offset:4608
    ds_read_b128 v[68:71], v138 offset:40960
    s_add_u32 m0, s49, 2048
    v_mfma_f32_32x32x16_bf16 v[32:47], v[128:131], v[76:79], v[32:47]
    buffer_load_dwordx4 v148, s[20:23], s54 offen lds
    v_mfma_f32_32x32x16_bf16 v[48:63], v[132:135], v[76:79], v[48:63]
    buffer_load_dwordx4 v149, s[20:23], s54 offen offset:1024 lds
    s_add_u32 s54, s54, 57344
    s_waitcnt vmcnt(16) lgkmcnt(0)
    v_mfma_f32_32x32x16_bf16 v[0:15], v[120:123], v[64:67], v[0:15]
    ds_read_b64_tr_b16 v[128:129], v144 offset:6144
    ds_read_b64_tr_b16 v[130:131], v144 offset:6656
    ds_read_b128 v[72:75], v139 offset:32768
    v_mfma_f32_32x32x16_bf16 v[16:31], v[124:127], v[64:67], v[16:31]
    ds_read_b64_tr_b16 v[132:133], v145 offset:6144
    ds_read_b64_tr_b16 v[134:135], v145 offset:6656
    ds_read_b128 v[76:79], v139 offset:40960
    s_add_u32 m0, s49, 4096
    v_mfma_f32_32x32x16_bf16 v[32:47], v[120:123], v[68:71], v[32:47]
    buffer_load_dwordx4 v148, s[20:23], s54 offen lds
    v_mfma_f32_32x32x16_bf16 v[48:63], v[124:127], v[68:71], v[48:63]
    buffer_load_dwordx4 v149, s[20:23], s54 offen offset:1024 lds
    s_add_u32 s54, s54, 57344
    s_waitcnt vmcnt(12) lgkmcnt(0)
    v_mfma_f32_32x32x16_bf16 v[0:15], v[128:131], v[72:75], v[0:15]
    ds_read_b64_tr_b16 v[120:121], v144 offset:8192
    ds_read_b64_tr_b16 v[122:123], v144 offset:8704
    ds_read_b128 v[64:67], v140 offset:32768
    v_mfma_f32_32x32x16_bf16 v[16:31], v[132:135], v[72:75], v[16:31]
    ds_read_b64_tr_b16 v[124:125], v145 offset:8192
    ds_read_b64_tr_b16 v[126:127], v145 offset:8704
    ds_read_b128 v[68:71], v140 offset:40960
    s_add_u32 m0, s49, 6144
    v_mfma_f32_32x32x16_bf16 v[32:47], v[128:131], v[76:79], v[32:47]
    buffer_load_dwordx4 v148, s[20:23], s54 offen lds
    v_mfma_f32_32x32x16_bf16 v[48:63], v[132:135], v[76:79], v[48:63]
    buffer_load_dwordx4 v149, s[20:23], s54 offen offset:1024 lds
    s_add_u32 s54, s54, 57344
    s_waitcnt vmcnt(12) lgkmcnt(0)
    v_mfma_f32_32x32x16_bf16 v[0:15], v[120:123], v[64:67], v[0:15]
    ds_read_b64_tr_b16 v[128:129], v144 offset:10240
    ds_read_b64_tr_b16 v[130:131], v144 offset:10752
    ds_read_b128 v[72:75], v141 offset:32768
    v_mfma_f32_32x32x16_bf16 v[16:31], v[124:127], v[64:67], v[16:31]
    ds_read_b64_tr_b16 v[132:133], v145 offset:10240
    ds_read_b64_tr_b16 v[134:135], v145 offset:10752
    ds_read_b128 v[76:79], v141 offset:40960
    s_add_u32 m0, s49, 8192
    v_mfma_f32_32x32x16_bf16 v[32:47], v[120:123], v[68:71], v[32:47]
    buffer_load_dwordx4 v148, s[20:23], s54 offen lds
    v_mfma_f32_32x32x16_bf16 v[48:63], v[124:127], v[68:71], v[48:63]
    buffer_load_dwordx4 v149, s[20:23], s54 offen offset:1024 lds
    s_add_u32 s54, s54, 57344
    s_waitcnt vmcnt(12) lgkmcnt(0)
    v_mfma_f32_32x32x16_bf16 v[0:15], v[128:131], v[72:75], v[0:15]
    ds_read_b64_tr_b16 v[120:121], v144 offset:12288
    ds_read_b64_tr_b16 v[122:123], v144 offset:12800
    ds_read_b128 v[64:67], v142 offset:32768
    v_mfma_f32_32x32x16_bf16 v[16:31], v[132:135], v[72:75], v[16:31]
    ds_read_b64_tr_b16 v[124:125], v145 offset:12288
    ds_read_b64_tr_b16 v[126:127], v145 offset:12800
    ds_read_b128 v[68:71], v142 offset:40960
    s_add_u32 m0, s49, 10240
    v_mfma_f32_32x32x16_bf16 v[32:47], v[128:131], v[76:79], v[32:47]
    buffer_load_dwordx4 v148, s[20:23], s54 offen lds
    v_mfma_f32_32x32x16_bf16 v[48:63], v[132:135], v[76:79], v[48:63]
    buffer_load_dwordx4 v149, s[20:23], s54 offen offset:1024 lds
    s_add_u32 s54, s54, 57344
    s_waitcnt vmcnt(12) lgkmcnt(0)
    v_mfma_f32_32x32x16_bf16 v[0:15], v[120:123], v[64:67], v[0:15]
    ds_read_b64_tr_b16 v[128:129], v144 offset:14336
    ds_read_b64_tr_b16 v[130:131], v144 offset:14848
    ds_read_b128 v[72:75], v143 offset:32768
    v_mfma_f32_32x32x16_bf16 v[16:31], v[124:127], v[64:67], v[16:31]
    ds_read_b64_tr_b16 v[132:133], v145 offset:14336
    ds_read_b64_tr_b16 v[134:135], v145 offset:14848
    ds_read_b128 v[76:79], v143 offset:40960
    s_add_u32 m0, s49, 12288
    v_mfma_f32_32x32x16_bf16 v[32:47], v[120:123], v[68:71], v[32:47]
    buffer_load_dwordx4 v148, s[20:23], s54 offen lds
    v_mfma_f32_32x32x16_bf16 v[48:63], v[124:127], v[68:71], v[48:63]
    buffer_load_dwordx4 v149, s[20:23], s54 offen offset:1024 lds
    s_add_u32 s54, s54, 57344
    s_waitcnt vmcnt(12) lgkmcnt(0)
    v_mfma_f32_32x32x16_bf16 v[0:15], v[128:131], v[72:75], v[0:15]
    ds_read_b64_tr_b16 v[120:121], v144 offset:0
    ds_read_b64_tr_b16 v[122:123], v144 offset:512
    ds_read_b128 v[64:67], v136 offset:49152
    v_mfma_f32_32x32x16_bf16 v[16:31], v[132:135], v[72:75], v[16:31]
    ds_read_b64_tr_b16 v[124:125], v145 offset:0
    ds_read_b64_tr_b16 v[126:127], v145 offset:512
    ds_read_b128 v[68:71], v136 offset:57344
    s_add_u32 m0, s49, 14336
    v_mfma_f32_32x32x16_bf16 v[32:47], v[128:131], v[76:79], v[32:47]
    buffer_load_dwordx4 v148, s[20:23], s54 offen lds
    s_mov_b64 exec, 1
    ds_add_u32 v177, v167 offset:8
    s_mov_b64 exec, -1
    v_mfma_f32_32x32x16_bf16 v[48:63], v[132:135], v[76:79], v[48:63]
    buffer_load_dwordx4 v149, s[20:23], s54 offen offset:1024 lds
    s_mul_i32 s54, s6, 114688
    s_add_u32 s54, s54, s4
    s_waitcnt vmcnt(12) lgkmcnt(0)
    v_mfma_f32_32x32x16_bf16 v[0:15], v[120:123], v[64:67], v[0:15]
    ds_read_b64_tr_b16 v[128:129], v144 offset:2048
    ds_read_b64_tr_b16 v[130:131], v144 offset:2560
    ds_read_b128 v[72:75], v137 offset:49152
    v_mfma_f32_32x32x16_bf16 v[16:31], v[124:127], v[64:67], v[16:31]
    ds_read_b64_tr_b16 v[132:133], v145 offset:2048
    ds_read_b64_tr_b16 v[134:135], v145 offset:2560
    ds_read_b128 v[76:79], v137 offset:57344
    s_add_u32 m0, s49, 0
    v_mfma_f32_32x32x16_bf16 v[32:47], v[120:123], v[68:71], v[32:47]
    buffer_load_dwordx4 v150, s[28:31], s54 offen offset:0 lds
    v_mfma_f32_32x32x16_bf16 v[48:63], v[124:127], v[68:71], v[48:63]
    buffer_load_dwordx4 v151, s[28:31], s54 offen offset:1024 lds
    s_add_u32 s54, s54, 16384
    s_waitcnt vmcnt(12) lgkmcnt(0)
    v_mfma_f32_32x32x16_bf16 v[0:15], v[128:131], v[72:75], v[0:15]
    ds_read_b64_tr_b16 v[120:121], v144 offset:4096
    ds_read_b64_tr_b16 v[122:123], v144 offset:4608
    ds_read_b128 v[64:67], v138 offset:49152
    v_mfma_f32_32x32x16_bf16 v[16:31], v[132:135], v[72:75], v[16:31]
    ds_read_b64_tr_b16 v[124:125], v145 offset:4096
    ds_read_b64_tr_b16 v[126:127], v145 offset:4608
    ds_read_b128 v[68:71], v138 offset:57344
    s_add_u32 m0, s49, 2048
    v_mfma_f32_32x32x16_bf16 v[32:47], v[128:131], v[76:79], v[32:47]
    buffer_load_dwordx4 v150, s[28:31], s54 offen offset:0 lds
    v_mfma_f32_32x32x16_bf16 v[48:63], v[132:135], v[76:79], v[48:63]
    buffer_load_dwordx4 v151, s[28:31], s54 offen offset:1024 lds
    s_add_u32 s54, s54, 16384
    s_waitcnt vmcnt(12) lgkmcnt(0)
    v_mfma_f32_32x32x16_bf16 v[0:15], v[120:123], v[64:67], v[0:15]
    ds_read_b64_tr_b16 v[128:129], v144 offset:6144
    ds_read_b64_tr_b16 v[130:131], v144 offset:6656
    ds_read_b128 v[72:75], v139 offset:49152
    v_mfma_f32_32x32x16_bf16 v[16:31], v[124:127], v[64:67], v[16:31]
    ds_read_b64_tr_b16 v[132:133], v145 offset:6144
    ds_read_b64_tr_b16 v[134:135], v145 offset:6656
    ds_read_b128 v[76:79], v139 offset:57344
    s_add_u32 m0, s49, 4096
    v_mfma_f32_32x32x16_bf16 v[32:47], v[120:123], v[68:71], v[32:47]
    buffer_load_dwordx4 v150, s[28:31], s54 offen offset:0 lds
    v_mfma_f32_32x32x16_bf16 v[48:63], v[124:127], v[68:71], v[48:63]
    buffer_load_dwordx4 v151, s[28:31], s54 offen offset:1024 lds
    s_add_u32 s54, s54, 16384
    s_waitcnt vmcnt(12) lgkmcnt(0)
    v_mfma_f32_32x32x16_bf16 v[0:15], v[128:131], v[72:75], v[0:15]
    ds_read_b64_tr_b16 v[120:121], v144 offset:8192
    ds_read_b64_tr_b16 v[122:123], v144 offset:8704
    ds_read_b128 v[64:67], v140 offset:49152
    v_mfma_f32_32x32x16_bf16 v[16:31], v[132:135], v[72:75], v[16:31]
    ds_read_b64_tr_b16 v[124:125], v145 offset:8192
    ds_read_b64_tr_b16 v[126:127], v145 offset:8704
    ds_read_b128 v[68:71], v140 offset:57344
    s_add_u32 m0, s49, 6144
    v_mfma_f32_32x32x16_bf16 v[32:47], v[128:131], v[76:79], v[32:47]
    buffer_load_dwordx4 v150, s[28:31], s54 offen offset:0 lds
    v_mfma_f32_32x32x16_bf16 v[48:63], v[132:135], v[76:79], v[48:63]
    buffer_load_dwordx4 v151, s[28:31], s54 offen offset:1024 lds
    s_add_u32 s54, s54, 16384
    s_waitcnt vmcnt(12) lgkmcnt(0)
    v_mfma_f32_32x32x16_bf16 v[0:15], v[120:123], v[64:67], v[0:15]
    ds_read_b64_tr_b16 v[128:129], v144 offset:10240
    ds_read_b64_tr_b16 v[130:131], v144 offset:10752
    ds_read_b128 v[72:75], v141 offset:49152
    v_mfma_f32_32x32x16_bf16 v[16:31], v[124:127], v[64:67], v[16:31]
    ds_read_b64_tr_b16 v[132:133], v145 offset:10240
    ds_read_b64_tr_b16 v[134:135], v145 offset:10752
    ds_read_b128 v[76:79], v141 offset:57344
    s_add_u32 m0, s49, 8192
    v_mfma_f32_32x32x16_bf16 v[32:47], v[120:123], v[68:71], v[32:47]
    buffer_load_dwordx4 v150, s[28:31], s54 offen offset:0 lds
    v_mfma_f32_32x32x16_bf16 v[48:63], v[124:127], v[68:71], v[48:63]
    buffer_load_dwordx4 v151, s[28:31], s54 offen offset:1024 lds
    s_add_u32 s54, s54, 16384
    s_waitcnt vmcnt(12) lgkmcnt(0)
    v_mfma_f32_32x32x16_bf16 v[0:15], v[128:131], v[72:75], v[0:15]
    ds_read_b64_tr_b16 v[120:121], v144 offset:12288
    ds_read_b64_tr_b16 v[122:123], v144 offset:12800
    ds_read_b128 v[64:67], v142 offset:49152
    v_mfma_f32_32x32x16_bf16 v[16:31], v[132:135], v[72:75], v[16:31]
    ds_read_b64_tr_b16 v[124:125], v145 offset:12288
    ds_read_b64_tr_b16 v[126:127], v145 offset:12800
    ds_read_b128 v[68:71], v142 offset:57344
    s_add_u32 m0, s49, 10240
    v_mfma_f32_32x32x16_bf16 v[32:47], v[128:131], v[76:79], v[32:47]
    buffer_load_dwordx4 v150, s[28:31], s54 offen offset:0 lds
    v_mfma_f32_32x32x16_bf16 v[48:63], v[132:135], v[76:79], v[48:63]
    buffer_load_dwordx4 v151, s[28:31], s54 offen offset:1024 lds
    s_add_u32 s54, s54, 16384
    s_waitcnt vmcnt(12) lgkmcnt(0)
    v_mfma_f32_32x32x16_bf16 v[0:15], v[120:123], v[64:67], v[0:15]
    ds_read_b64_tr_b16 v[128:129], v144 offset:14336
    ds_read_b64_tr_b16 v[130:131], v144 offset:14848
    ds_read_b128 v[72:75], v143 offset:49152
    v_mfma_f32_32x32x16_bf16 v[16:31], v[124:127], v[64:67], v[16:31]
    ds_read_b64_tr_b16 v[132:133], v145 offset:14336
    ds_read_b64_tr_b16 v[134:135], v145 offset:14848
    ds_read_b128 v[76:79], v143 offset:57344
    s_add_u32 m0, s49, 12288
    v_mfma_f32_32x32x16_bf16 v[32:47], v[120:123], v[68:71], v[32:47]
    buffer_load_dwordx4 v150, s[28:31], s54 offen offset:0 lds
    v_mfma_f32_32x32x16_bf16 v[48:63], v[124:127], v[68:71], v[48:63]
    buffer_load_dwordx4 v151, s[28:31], s54 offen offset:1024 lds
    s_add_u32 s54, s7, 114688
    s_waitcnt vmcnt(63) lgkmcnt(0)
    v_mfma_f32_32x32x16_bf16 v[0:15], v[128:131], v[72:75], v[0:15]
    v_mfma_f32_32x32x16_bf16 v[16:31], v[132:135], v[72:75], v[16:31]
    s_add_u32 m0, s49, 14336
    v_mfma_f32_32x32x16_bf16 v[32:47], v[128:131], v[76:79], v[32:47]
    buffer_load_dwordx4 v150, s[16:19], s54 offen offset:0 lds
    s_mov_b64 exec, 1
    ds_add_u32 v177, v167 offset:12
    s_mov_b64 exec, -1
    v_mfma_f32_32x32x16_bf16 v[48:63], v[132:135], v[76:79], v[48:63]
    buffer_load_dwordx4 v151, s[16:19], s54 offen offset:1024 lds
    s_waitcnt vmcnt(40)
    s_branch L_F1done
L_F1w3:
    s_add_u32 m0, s49, 0
    s_nop 0
    buffer_load_dwordx4 v148, s[20:23], s54 offen lds
    s_add_u32 s54, s54, 57344
    s_add_u32 m0, s49, 2048
    s_nop 0
    buffer_load_dwordx4 v148, s[20:23], s54 offen lds
    s_add_u32 s54, s54, 57344
    s_add_u32 m0, s49, 4096
    s_nop 0
    buffer_load_dwordx4 v148, s[20:23], s54 offen lds
    s_add_u32 s54, s54, 57344
    s_add_u32 m0, s49, 6144
    s_nop 0
    buffer_load_dwordx4 v148, s[20:23], s54 offen lds
    s_add_u32 s54, s54, 57344
    s_add_u32 m0, s49, 8192
    s_nop 0
    buffer_load_dwordx4 v148, s[20:23], s54 offen lds
    s_add_u32 s54, s54, 57344
    s_add_u32 m0, s49, 10240
    s_nop 0
    buffer_load_dwordx4 v148, s[20:23], s54 offen lds
    s_add_u32 s54, s54, 57344
    s_add_u32 m0, s49, 12288
    s_nop 0
    buffer_load_dwordx4 v148, s[20:23], s54 offen lds
    s_add_u32 s54, s54, 57344
    s_add_u32 m0, s49, 14336
    s_nop 0
    buffer_load_dwordx4 v148, s[20:23], s54 offen lds
    s_add_u32 s55, s3, 1
    s_and_b32 s55, s55, 3
    s_mul_i32 s55, s55, 458752
    s_add_u32 s54, s100, s55
    s_setprio 3
    v_mov_b64 v[124:125], 0
    v_mov_b64 v[126:127], 0
    v_mov_b64 v[132:133], 0
    v_mov_b64 v[134:135], 0
    s_mov_b32 s36, 0x10100101
    s_mov_b32 s37, 0x10100101
    s_setprio 0
    s_waitcnt vmcnt(7)
    ds_read_b64_tr_b16 v[120:121], v144 offset:0
    ds_read_b64_tr_b16 v[122:123], v144 offset:256
    ds_read_b128 v[64:67], v136 offset:0
    s_mov_b64 exec, s[36:37]
    ds_read_b128 v[124:127], v145 offset:0
    s_mov_b64 exec, -1
    ds_read_b128 v[68:71], v136 offset:8192
    v_mfma_f32_32x32x16_bf16 v[0:15], v[152:155], v[160:163], 0
    v_mfma_f32_32x32x16_bf16 v[32:47], v[152:155], v[160:163], 0
    s_waitcnt vmcnt(6) lgkmcnt(0)
    v_mfma_f32_32x32x16_bf16 v[0:15], v[120:123], v[64:67], v[0:15]
    ds_read_b64_tr_b16 v[128:129], v144 offset:2048
    ds_read_b64_tr_b16 v[130:131], v144 offset:2304
    ds_read_b128 v[72:75], v137 offset:0
    v_mfma_f32_16x16x32_bf16 v[16:19], v[124:127], v[64:67], 0
    s_mov_b64 exec, s[36:37]
    ds_read_b128 v[132:135], v145 offset:32
    s_mov_b64 exec, -1
    ds_read_b128 v[76:79], v137 offset:8192
    v_mfma_f32_32x32x16_bf16 v[32:47], v[120:123], v[68:71], v[32:47]
    v_mfma_f32_16x16x32_bf16 v[48:51], v[124:127], v[68:71], 0
    s_waitcnt vmcnt(5) lgkmcnt(0)
    v_mfma_f32_32x32x16_bf16 v[0:15], v[128:131], v[72:75], v[0:15]
    ds_read_b64_tr_b16 v[120:121], v144 offset:4096
    ds_read_b64_tr_b16 v[122:123], v144 offset:4352
    ds_read_b128 v[64:67], v138 offset:0
    v_mfma_f32_16x16x32_bf16 v[16:19], v[132:135], v[72:75], v[16:19]
    s_mov_b64 exec, s[36:37]
    ds_read_b128 v[124:127], v145 offset:64
    s_mov_b64 exec, -1
    ds_read_b128 v[68:71], v138 offset:8192
    v_mfma_f32_32x32x16_bf16 v[32:47], v[128:131], v[76:79], v[32:47]
    v_mfma_f32_16x16x32_bf16 v[48:51], v[132:135], v[76:79], v[48:51]
    s_waitcnt vmcnt(4) lgkmcnt(0)
    v_mfma_f32_32x32x16_bf16 v[0:15], v[120:123], v[64:67], v[0:15]
    ds_read_b64_tr_b16 v[128:129], v144 offset:6144
    ds_read_b64_tr_b16 v[130:131], v144 offset:6400
    ds_read_b128 v[72:75], v139 offset:0
    v_mfma_f32_16x16x32_bf16 v[16:19], v[124:127], v[64:67], v[16:19]
    s_mov_b64 exec, s[36:37]
    ds_read_b128 v[132:135], v145 offset:96
    s_mov_b64 exec, -1
    ds_read_b128 v[76:79], v139 offset:8192
    v_mfma_f32_32x32x16_bf16 v[32:47], v[120:123], v[68:71], v[32:47]
    v_mfma_f32_16x16x32_bf16 v[48:51], v[124:127], v[68:71], v[48:51]
    s_waitcnt vmcnt(3) lgkmcnt(0)
    v_mfma_f32_32x32x16_bf16 v[0:15], v[128:131], v[72:75], v[0:15]
    ds_read_b64_tr_b16 v[120:121], v144 offset:8192
    ds_read_b64_tr_b16 v[122:123], v144 offset:8448
    ds_read_b128 v[64:67], v140 offset:0
    v_mfma_f32_16x16x32_bf16 v[16:19], v[132:135], v[72:75], v[16:19]
    s_mov_b64 exec, s[36:37]
    ds_read_b128 v[124:127], v145 offset:128
    s_mov_b64 exec, -1
    ds_read_b128 v[68:71], v140 offset:8192
    v_mfma_f32_32x32x16_bf16 v[32:47], v[128:131], v[76:79], v[32:47]
    v_mfma_f32_16x16x32_bf16 v[48:51], v[132:135], v[76:79], v[48:51]
    s_waitcnt vmcnt(2) lgkmcnt(0)
    v_mfma_f32_32x32x16_bf16 v[0:15], v[120:123], v[64:67], v[0:15]
    ds_read_b64_tr_b16 v[128:129], v144 offset:10240
    ds_read_b64_tr_b16 v[130:131], v144 offset:10496
    ds_read_b128 v[72:75], v141 offset:0
    v_mfma_f32_16x16x32_bf16 v[16:19], v[124:127], v[64:67], v[16:19]
    s_mov_b64 exec, s[36:37]
    ds_read_b128 v[132:135], v145 offset:160
    s_mov_b64 exec, -1
    ds_read_b128 v[76:79], v141 offset:8192
    v_mfma_f32_32x32x16_bf16 v[32:47], v[120:123], v[68:71], v[32:47]
    v_mfma_f32_16x16x32_bf16 v[48:51], v[124:127], v[68:71], v[48:51]
    s_waitcnt vmcnt(1) lgkmcnt(0)
    v_mfma_f32_32x32x16_bf16 v[0:15], v[128:131], v[72:75], v[0:15]
    ds_read_b64_tr_b16 v[120:121], v144 offset:12288
    ds_read_b64_tr_b16 v[122:123], v144 offset:12544
    ds_read_b128 v[64:67], v142 offset:0
    v_mfma_f32_16x16x32_bf16 v[16:19], v[132:135], v[72:75], v[16:19]
    s_mov_b64 exec, s[36:37]
    ds_read_b128 v[124:127], v145 offset:192
    s_mov_b64 exec, -1
    ds_read_b128 v[68:71], v142 offset:8192
    v_mfma_f32_32x32x16_bf16 v[32:47], v[128:131], v[76:79], v[32:47]
    v_mfma_f32_16x16x32_bf16 v[48:51], v[132:135], v[76:79], v[48:51]
    s_waitcnt vmcnt(0) lgkmcnt(0)
    v_mfma_f32_32x32x16_bf16 v[0:15], v[120:123], v[64:67], v[0:15]
    ds_read_b64_tr_b16 v[128:129], v144 offset:14336
    ds_read_b64_tr_b16 v[130:131], v144 offset:14592
    ds_read_b128 v[72:75], v143 offset:0
    v_mfma_f32_16x16x32_bf16 v[16:19], v[124:127], v[64:67], v[16:19]
    s_mov_b64 exec, s[36:37]
    ds_read_b128 v[132:135], v145 offset:224
    s_mov_b64 exec, -1
    ds_read_b128 v[76:79], v143 offset:8192
    v_mfma_f32_32x32x16_bf16 v[32:47], v[120:123], v[68:71], v[32:47]
    v_mfma_f32_16x16x32_bf16 v[48:51], v[124:127], v[68:71], v[48:51]
    s_waitcnt vmcnt(63) lgkmcnt(0)
    v_mfma_f32_32x32x16_bf16 v[0:15], v[128:131], v[72:75], v[0:15]
    v_mfma_f32_16x16x32_bf16 v[16:19], v[132:135], v[72:75], v[16:19]
    v_mfma_f32_32x32x16_bf16 v[32:47], v[128:131], v[76:79], v[32:47]
    s_mov_b64 exec, 1
    ds_add_u32 v177, v167 offset:0
    s_mov_b64 exec, -1
    v_mfma_f32_16x16x32_bf16 v[48:51], v[132:135], v[76:79], v[48:51]
    s_setprio 3
    s_mov_b32 s63, 0
L_gob:
    ds_read_b32 v178, v177 offset:84
    s_add_u32 s63, s63, 1
    s_cmp_gt_u32 s63, 1000000
    s_cbranch_scc1 L_gob_x
    s_waitcnt lgkmcnt(0)
    v_cmp_ne_u32 vcc, s53, v178
    s_cbranch_vccz L_gob_x
    s_sleep 2
    s_branch L_gob
L_gob_x:
    s_setprio 0
    s_add_u32 m0, s49, 0
    s_nop 0
    buffer_load_dwordx4 v148, s[20:23], s54 offen lds
    s_add_u32 s54, s54, 57344
    s_add_u32 m0, s49, 2048
    s_nop 0
    buffer_load_dwordx4 v148, s[20:23], s54 offen lds
    s_add_u32 s54, s54, 57344
    s_add_u32 m0, s49, 4096
    s_nop 0
    buffer_load_dwordx4 v148, s[20:23], s54 offen lds
    s_add_u32 s54, s54, 57344
    s_add_u32 m0, s49, 6144
    s_nop 0
    buffer_load_dwordx4 v148, s[20:23], s54 offen lds
    s_add_u32 s54, s54, 57344
    s_add_u32 m0, s49, 8192
    s_nop 0
    buffer_load_dwordx4 v148, s[20:23], s54 offen lds
    s_add_u32 s54, s54, 57344
    s_add_u32 m0, s49, 10240
    s_nop 0
    buffer_load_dwordx4 v148, s[20:23], s54 offen lds
    s_add_u32 s54, s54, 57344
    s_add_u32 m0, s49, 12288
    s_nop 0
    buffer_load_dwordx4 v148, s[20:23], s54 offen lds
    s_add_u32 s54, s54, 57344
    s_add_u32 m0, s49, 14336
    s_nop 0
    buffer_load_dwordx4 v148, s[20:23], s54 offen lds
    s_add_u32 s55, s3, 2
    s_and_b32 s55, s55, 3
    s_mul_i32 s55, s55, 458752
    s_add_u32 s54, s100, s55
    s_waitcnt vmcnt(7)
    ds_read_b64_tr_b16 v[120:121], v144 offset:0
    ds_read_b64_tr_b16 v[122:123], v144 offset:256
    ds_read_b128 v[64:67], v136 offset:16384
    s_mov_b64 exec, s[36:37]
    ds_read_b128 v[124:127], v145 offset:256
    s_mov_b64 exec, -1
    ds_read_b128 v[68:71], v136 offset:24576
    s_waitcnt vmcnt(6) lgkmcnt(0)
    v_mfma_f32_32x32x16_bf16 v[0:15], v[120:123], v[64:67], v[0:15]
    ds_read_b64_tr_b16 v[128:129], v144 offset:2048
    ds_read_b64_tr_b16 v[130:131], v144 offset:2304
    ds_read_b128 v[72:75], v137 offset:16384
    v_mfma_f32_16x16x32_bf16 v[16:19], v[124:127], v[64:67], v[16:19]
    s_mov_b64 exec, s[36:37]
    ds_read_b128 v[132:135], v145 offset:288
    s_mov_b64 exec, -1
    ds_read_b128 v[76:79], v137 offset:24576
    s_add_u32 m0, s49, 0
    v_mfma_f32_32x32x16_bf16 v[32:47], v[120:123], v[68:71], v[32:47]
    buffer_load_dwordx4 v148, s[20:23], s54 offen lds
    v_mfma_f32_16x16x32_bf16 v[48:51], v[124:127], v[68:71], v[48:51]
    s_add_u32 s54, s54, 57344
    s_waitcnt vmcnt(6) lgkmcnt(0)
    v_mfma_f32_32x32x16_bf16 v[0:15], v[128:131], v[72:75], v[0:15]
    ds_read_b64_tr_b16 v[120:121], v144 offset:4096
    ds_read_b64_tr_b16 v[122:123], v144 offset:4352
    ds_read_b128 v[64:67], v138 offset:16384
    v_mfma_f32_16x16x32_bf16 v[16:19], v[132:135], v[72:75], v[16:19]
    s_mov_b64 exec, s[36:37]
    ds_read_b128 v[124:127], v145 offset:320
    s_mov_b64 exec, -1
    ds_read_b128 v[68:71], v138 offset:24576
    s_add_u32 m0, s49, 2048
    v_mfma_f32_32x32x16_bf16 v[32:47], v[128:131], v[76:79], v[32:47]
    buffer_load_dwordx4 v148, s[20:23], s54 offen lds
    v_mfma_f32_16x16x32_bf16 v[48:51], v[132:135], v[76:79], v[48:51]
    s_add_u32 s54, s54, 57344
    s_waitcnt vmcnt(6) lgkmcnt(0)
    v_mfma_f32_32x32x16_bf16 v[0:15], v[120:123], v[64:67], v[0:15]
    ds_read_b64_tr_b16 v[128:129], v144 offset:6144
    ds_read_b64_tr_b16 v[130:131], v144 offset:6400
    ds_read_b128 v[72:75], v139 offset:16384
    v_mfma_f32_16x16x32_bf16 v[16:19], v[124:127], v[64:67], v[16:19]
    s_mov_b64 exec, s[36:37]
    ds_read_b128 v[132:135], v145 offset:352
    s_mov_b64 exec, -1
    ds_read_b128 v[76:79], v139 offset:24576
    s_add_u32 m0, s49, 4096
    v_mfma_f32_32x32x16_bf16 v[32:47], v[120:123], v[68:71], v[32:47]
    buffer_load_dwordx4 v148, s[20:23], s54 offen lds
    v_mfma_f32_16x16x32_bf16 v[48:51], v[124:127], v[68:71], v[48:51]
    s_add_u32 s54, s54, 57344
    s_waitcnt vmcnt(6) lgkmcnt(0)
    v_mfma_f32_32x32x16_bf16 v[0:15], v[128:131], v[72:75], v[0:15]
    ds_read_b64_tr_b16 v[120:121], v144 offset:8192
    ds_read_b64_tr_b16 v[122:123], v144 offset:8448
    ds_read_b128 v[64:67], v140 offset:16384
    v_mfma_f32_16x16x32_bf16 v[16:19], v[132:135], v[72:75], v[16:19]
    s_mov_b64 exec, s[36:37]
    ds_read_b128 v[124:127], v145 offset:384
    s_mov_b64 exec, -1
    ds_read_b128 v[68:71], v140 offset:24576
    s_add_u32 m0, s49, 6144
    v_mfma_f32_32x32x16_bf16 v[32:47], v[128:131], v[76:79], v[32:47]
    buffer_load_dwordx4 v148, s[20:23], s54 offen lds
    v_mfma_f32_16x16x32_bf16 v[48:51], v[132:135], v[76:79], v[48:51]
    s_add_u32 s54, s54, 57344
    buffer_store_dwordx4 v[200:203], v166, s[44:47], s8 offen sc1
    buffer_store_dwordx4 v[200:203], v166, s[44:47], s9 offen sc1
    buffer_load_dword v178, v180, s[44:47], s27 offen sc1
    buffer_load_dwordx2 v[194:195], v180, s[44:47], s64 offen sc1
    s_waitcnt vmcnt(10) lgkmcnt(0)
    v_mfma_f32_32x32x16_bf16 v[0:15], v[120:123], v[64:67], v[0:15]
    ds_read_b64_tr_b16 v[128:129], v144 offset:10240
    ds_read_b64_tr_b16 v[130:131], v144 offset:10496
    ds_read_b128 v[72:75], v141 offset:16384
    v_mfma_f32_16x16x32_bf16 v[16:19], v[124:127], v[64:67], v[16:19]
    s_mov_b64 exec, s[36:37]
    ds_read_b128 v[132:135], v145 offset:416
    s_mov_b64 exec, -1
    ds_read_b128 v[76:79], v141 offset:24576
    s_add_u32 m0, s49, 8192
    v_mfma_f32_32x32x16_bf16 v[32:47], v[120:123], v[68:71], v[32:47]
    buffer_load_dwordx4 v148, s[20:23], s54 offen lds
    v_mfma_f32_16x16x32_bf16 v[48:51], v[124:127], v[68:71], v[48:51]
    s_add_u32 s54, s54, 57344
    s_waitcnt vmcnt(10) lgkmcnt(0)
    v_mfma_f32_32x32x16_bf16 v[0:15], v[128:131], v[72:75], v[0:15]
    ds_read_b64_tr_b16 v[120:121], v144 offset:12288
    ds_read_b64_tr_b16 v[122:123], v144 offset:12544
    ds_read_b128 v[64:67], v142 offset:16384
    v_mfma_f32_16x16x32_bf16 v[16:19], v[132:135], v[72:75], v[16:19]
    s_mov_b64 exec, s[36:37]
    ds_read_b128 v[124:127], v145 offset:448
    s_mov_b64 exec, -1
    ds_read_b128 v[68:71], v142 offset:24576
    s_add_u32 m0, s49, 10240
    v_mfma_f32_32x32x16_bf16 v[32:47], v[128:131], v[76:79], v[32:47]
    buffer_load_dwordx4 v148, s[20:23], s54 offen lds
    v_mfma_f32_16x16x32_bf16 v[48:51], v[132:135], v[76:79], v[48:51]
    s_add_u32 s54, s54, 57344
    s_waitcnt vmcnt(10) lgkmcnt(0)
    v_mfma_f32_32x32x16_bf16 v[0:15], v[120:123], v[64:67], v[0:15]
    ds_read_b64_tr_b16 v[128:129], v144 offset:14336
    ds_read_b64_tr_b16 v[130:131], v144 offset:14592
    ds_read_b128 v[72:75], v143 offset:16384
    v_mfma_f32_16x16x32_bf16 v[16:19], v[124:127], v[64:67], v[16:19]
    s_mov_b64 exec, s[36:37]
    ds_read_b128 v[132:135], v145 offset:480
    s_mov_b64 exec, -1
    ds_read_b128 v[76:79], v143 offset:24576
    s_add_u32 m0, s49, 12288
    v_mfma_f32_32x32x16_bf16 v[32:47], v[120:123], v[68:71], v[32:47]
    buffer_load_dwordx4 v148, s[20:23], s54 offen lds
    v_mfma_f32_16x16x32_bf16 v[48:51], v[124:127], v[68:71], v[48:51]
    s_add_u32 s54, s54, 57344
    s_waitcnt vmcnt(10) lgkmcnt(0)
    v_mfma_f32_32x32x16_bf16 v[0:15], v[128:131], v[72:75], v[0:15]
    ds_read_b64_tr_b16 v[120:121], v144 offset:0
    ds_read_b64_tr_b16 v[122:123], v144 offset:256
    ds_read_b128 v[64:67], v136 offset:32768
    v_mfma_f32_16x16x32_bf16 v[16:19], v[132:135], v[72:75], v[16:19]
    s_mov_b64 exec, s[36:37]
    ds_read_b128 v[124:127], v145 offset:512
    s_mov_b64 exec, -1
    ds_read_b128 v[68:71], v136 offset:40960
    s_add_u32 m0, s49, 14336
    v_mfma_f32_32x32x16_bf16 v[32:47], v[128:131], v[76:79], v[32:47]
    buffer_load_dwordx4 v148, s[20:23], s54 offen lds
    s_mov_b64 exec, 1
    ds_add_u32 v177, v167 offset:4
    s_mov_b64 exec, -1
    v_mfma_f32_16x16x32_bf16 v[48:51], v[132:135], v[76:79], v[48:51]
    s_add_u32 s55, s3, 3
    s_and_b32 s55, s55, 3
    s_mul_i32 s55, s55, 458752
    s_add_u32 s54, s100, s55
    s_waitcnt vmcnt(10) lgkmcnt(0)
    v_mfma_f32_32x32x16_bf16 v[0:15], v[120:123], v[64:67], v[0:15]
    ds_read_b64_tr_b16 v[128:129], v144 offset:2048
    ds_read_b64_tr_b16 v[130:131], v144 offset:2304
    ds_read_b128 v[72:75], v137 offset:32768
    v_mfma_f32_16x16x32_bf16 v[16:19], v[124:127], v[64:67], v[16:19]
    s_mov_b64 exec, s[36:37]
    ds_read_b128 v[132:135], v145 offset:544
    s_mov_b64 exec, -1
    ds_read_b128 v[76:79], v137 offset:40960
    s_add_u32 m0, s49, 0
    v_mfma_f32_32x32x16_bf16 v[32:47], v[120:123], v[68:71], v[32:47]
    buffer_load_dwordx4 v148, s[20:23], s54 offen lds
    v_mfma_f32_16x16x32_bf16 v[48:51], v[124:127], v[68:71], v[48:51]
    s_add_u32 s54, s54, 57344
    s_waitcnt vmcnt(10) lgkmcnt(0)
    v_mfma_f32_32x32x16_bf16 v[0:15], v[128:131], v[72:75], v[0:15]
    ds_read_b64_tr_b16 v[120:121], v144 offset:4096
    ds_read_b64_tr_b16 v[122:123], v144 offset:4352
    ds_read_b128 v[64:67], v138 offset:32768
    v_mfma_f32_16x16x32_bf16 v[16:19], v[132:135], v[72:75], v[16:19]
    s_mov_b64 exec, s[36:37]
    ds_read_b128 v[124:127], v145 offset:576
    s_mov_b64 exec, -1
    ds_read_b128 v[68:71], v138 offset:40960
    s_add_u32 m0, s49, 2048
    v_mfma_f32_32x32x16_bf16 v[32:47], v[128:131], v[76:79], v[32:47]
    buffer_load_dwordx4 v148, s[20:23], s54 offen lds
    v_mfma_f32_16x16x32_bf16 v[48:51], v[132:135], v[76:79], v[48:51]
    s_add_u32 s54, s54, 57344
    s_waitcnt vmcnt(10) lgkmcnt(0)
    v_mfma_f32_32x32x16_bf16 v[0:15], v[120:123], v[64:67], v[0:15]
    ds_read_b64_tr_b16 v[128:129], v144 offset:6144
    ds_read_b64_tr_b16 v[130:131], v144 offset:6400
    ds_read_b128 v[72:75], v139 offset:32768
    v_mfma_f32_16x16x32_bf16 v[16:19], v[124:127], v[64:67], v[16:19]
    s_mov_b64 exec, s[36:37]
    ds_read_b128 v[132:135], v145 offset:608
    s_mov_b64 exec, -1
    ds_read_b128 v[76:79], v139 offset:40960
    s_add_u32 m0, s49, 4096
    v_mfma_f32_32x32x16_bf16 v[32:47], v[120:123], v[68:71], v[32:47]
    buffer_load_dwordx4 v148, s[20:23], s54 offen lds
    v_mfma_f32_16x16x32_bf16 v[48:51], v[124:127], v[68:71], v[48:51]
    s_add_u32 s54, s54, 57344
    s_waitcnt vmcnt(6) lgkmcnt(0)
    v_mfma_f32_32x32x16_bf16 v[0:15], v[128:131], v[72:75], v[0:15]
    ds_read_b64_tr_b16 v[120:121], v144 offset:8192
    ds_read_b64_tr_b16 v[122:123], v144 offset:8448
    ds_read_b128 v[64:67], v140 offset:32768
    v_mfma_f32_16x16x32_bf16 v[16:19], v[132:135], v[72:75], v[16:19]
    s_mov_b64 exec, s[36:37]
    ds_read_b128 v[124:127], v145 offset:640
    s_mov_b64 exec, -1
    ds_read_b128 v[68:71], v140 offset:40960
    s_add_u32 m0, s49, 6144
    v_mfma_f32_32x32x16_bf16 v[32:47], v[128:131], v[76:79], v[32:47]
    buffer_load_dwordx4 v148, s[20:23], s54 offen lds
    v_mfma_f32_16x16x32_bf16 v[48:51], v[132:135], v[76:79], v[48:51]
    s_add_u32 s54, s54, 57344
    s_waitcnt vmcnt(6) lgkmcnt(0)
    v_mfma_f32_32x32x16_bf16 v[0:15], v[120:123], v[64:67], v[0:15]
    ds_read_b64_tr_b16 v[128:129], v144 offset:10240
    ds_read_b64_tr_b16 v[130:131], v144 offset:10496
    ds_read_b128 v[72:75], v141 offset:32768
    v_mfma_f32_16x16x32_bf16 v[16:19], v[124:127], v[64:67], v[16:19]
    s_mov_b64 exec, s[36:37]
    ds_read_b128 v[132:135], v145 offset:672
    s_mov_b64 exec, -1
    ds_read_b128 v[76:79], v141 offset:40960
    s_add_u32 m0, s49, 8192
    v_mfma_f32_32x32x16_bf16 v[32:47], v[120:123], v[68:71], v[32:47]
    buffer_load_dwordx4 v148, s[20:23], s54 offen lds
    v_mfma_f32_16x16x32_bf16 v[48:51], v[124:127], v[68:71], v[48:51]
    s_add_u32 s54, s54, 57344
    s_waitcnt vmcnt(6) lgkmcnt(0)
    v_mfma_f32_32x32x16_bf16 v[0:15], v[128:131], v[72:75], v[0:15]
    ds_read_b64_tr_b16 v[120:121], v144 offset:12288
    ds_read_b64_tr_b16 v[122:123], v144 offset:12544
    ds_read_b128 v[64:67], v142 offset:32768
    v_mfma_f32_16x16x32_bf16 v[16:19], v[132:135], v[72:75], v[16:19]
    s_mov_b64 exec, s[36:37]
    ds_read_b128 v[124:127], v145 offset:704
    s_mov_b64 exec, -1
    ds_read_b128 v[68:71], v142 offset:40960
    s_add_u32 m0, s49, 10240
    v_mfma_f32_32x32x16_bf16 v[32:47], v[128:131], v[76:79], v[32:47]
    buffer_load_dwordx4 v148, s[20:23], s54 offen lds
    v_mfma_f32_16x16x32_bf16 v[48:51], v[132:135], v[76:79], v[48:51]
    s_add_u32 s54, s54, 57344
    s_waitcnt vmcnt(6) lgkmcnt(0)
    v_mfma_f32_32x32x16_bf16 v[0:15], v[120:123], v[64:67], v[0:15]
    ds_read_b64_tr_b16 v[128:129], v144 offset:14336
    ds_read_b64_tr_b16 v[130:131], v144 offset:14592
    ds_read_b128 v[72:75], v143 offset:32768
    v_mfma_f32_16x16x32_bf16 v[16:19], v[124:127], v[64:67], v[16:19]
    s_mov_b64 exec, s[36:37]
    ds_read_b128 v[132:135], v145 offset:736
    s_mov_b64 exec, -1
    ds_read_b128 v[76:79], v143 offset:40960
    s_add_u32 m0, s49, 12288
    v_mfma_f32_32x32x16_bf16 v[32:47], v[120:123], v[68:71], v[32:47]
    buffer_load_dwordx4 v148, s[20:23], s54 offen lds
    v_mfma_f32_16x16x32_bf16 v[48:51], v[124:127], v[68:71], v[48:51]
    s_add_u32 s54, s54, 57344
    s_waitcnt vmcnt(6) lgkmcnt(0)
    v_mfma_f32_32x32x16_bf16 v[0:15], v[128:131], v[72:75], v[0:15]
    ds_read_b64_tr_b16 v[120:121], v144 offset:0
    ds_read_b64_tr_b16 v[122:123], v144 offset:256
    ds_read_b128 v[64:67], v136 offset:49152
    v_mfma_f32_16x16x32_bf16 v[16:19], v[132:135], v[72:75], v[16:19]
    s_mov_b64 exec, s[36:37]
    ds_read_b128 v[124:127], v145 offset:768
    s_mov_b64 exec, -1
    ds_read_b128 v[68:71], v136 offset:57344
    s_add_u32 m0, s49, 14336
    v_mfma_f32_32x32x16_bf16 v[32:47], v[128:131], v[76:79], v[32:47]
    buffer_load_dwordx4 v148, s[20:23], s54 offen lds
    s_mov_b64 exec, 1
    ds_add_u32 v177, v167 offset:8
    s_mov_b64 exec, -1
    v_mfma_f32_16x16x32_bf16 v[48:51], v[132:135], v[76:79], v[48:51]
    s_mul_i32 s54, s6, 114688
    s_add_u32 s54, s54, s4
    s_waitcnt vmcnt(6) lgkmcnt(0)
    v_mfma_f32_32x32x16_bf16 v[0:15], v[120:123], v[64:67], v[0:15]
    ds_read_b64_tr_b16 v[128:129], v144 offset:2048
    ds_read_b64_tr_b16 v[130:131], v144 offset:2304
    ds_read_b128 v[72:75], v137 offset:49152
    v_mfma_f32_16x16x32_bf16 v[16:19], v[124:127], v[64:67], v[16:19]
    s_mov_b64 exec, s[36:37]
    ds_read_b128 v[132:135], v145 offset:800
    s_mov_b64 exec, -1
    ds_read_b128 v[76:79], v137 offset:57344
    s_add_u32 m0, s49, 0
    v_mfma_f32_32x32x16_bf16 v[32:47], v[120:123], v[68:71], v[32:47]
    buffer_load_dwordx4 v150, s[28:31], s54 offen offset:0 lds
    v_mfma_f32_16x16x32_bf16 v[48:51], v[124:127], v[68:71], v[48:51]
    buffer_load_dwordx4 v151, s[28:31], s54 offen offset:1024 lds
    s_add_u32 s54, s54, 16384
    s_waitcnt vmcnt(7) lgkmcnt(0)
    v_mfma_f32_32x32x16_bf16 v[0:15], v[128:131], v[72:75], v[0:15]
    ds_read_b64_tr_b16 v[120:121], v144 offset:4096
    ds_read_b64_tr_b16 v[122:123], v144 offset:4352
    ds_read_b128 v[64:67], v138 offset:49152
    v_mfma_f32_16x16x32_bf16 v[16:19], v[132:135], v[72:75], v[16:19]
    s_mov_b64 exec, s[36:37]
    ds_read_b128 v[124:127], v145 offset:832
    s_mov_b64 exec, -1
    ds_read_b128 v[68:71], v138 offset:57344
    s_add_u32 m0, s49, 2048
    v_mfma_f32_32x32x16_bf16 v[32:47], v[128:131], v[76:79], v[32:47]
    buffer_load_dwordx4 v150, s[28:31], s54 offen offset:0 lds
    v_mfma_f32_16x16x32_bf16 v[48:51], v[132:135], v[76:79], v[48:51]
    buffer_load_dwordx4 v151, s[28:31], s54 offen offset:1024 lds
    s_add_u32 s54, s54, 16384
    s_waitcnt vmcnt(8) lgkmcnt(0)
    v_mfma_f32_32x32x16_bf16 v[0:15], v[120:123], v[64:67], v[0:15]
    ds_read_b64_tr_b16 v[128:129], v144 offset:6144
    ds_read_b64_tr_b16 v[130:131], v144 offset:6400
    ds_read_b128 v[72:75], v139 offset:49152
    v_mfma_f32_16x16x32_bf16 v[16:19], v[124:127], v[64:67], v[16:19]
    s_mov_b64 exec, s[36:37]
    ds_read_b128 v[132:135], v145 offset:864
    s_mov_b64 exec, -1
    ds_read_b128 v[76:79], v139 offset:57344
    s_add_u32 m0, s49, 4096
    v_mfma_f32_32x32x16_bf16 v[32:47], v[120:123], v[68:71], v[32:47]
    buffer_load_dwordx4 v150, s[28:31], s54 offen offset:0 lds
    v_mfma_f32_16x16x32_bf16 v[48:51], v[124:127], v[68:71], v[48:51]
    buffer_load_dwordx4 v151, s[28:31], s54 offen offset:1024 lds
    s_add_u32 s54, s54, 16384
    s_waitcnt vmcnt(9) lgkmcnt(0)
    v_mfma_f32_32x32x16_bf16 v[0:15], v[128:131], v[72:75], v[0:15]
    ds_read_b64_tr_b16 v[120:121], v144 offset:8192
    ds_read_b64_tr_b16 v[122:123], v144 offset:8448
    ds_read_b128 v[64:67], v140 offset:49152
    v_mfma_f32_16x16x32_bf16 v[16:19], v[132:135], v[72:75], v[16:19]
    s_mov_b64 exec, s[36:37]
    ds_read_b128 v[124:127], v145 offset:896
    s_mov_b64 exec, -1
    ds_read_b128 v[68:71], v140 offset:57344
    s_add_u32 m0, s49, 6144
    v_mfma_f32_32x32x16_bf16 v[32:47], v[128:131], v[76:79], v[32:47]
    buffer_load_dwordx4 v150, s[28:31], s54 offen offset:0 lds
    v_mfma_f32_16x16x32_bf16 v[48:51], v[132:135], v[76:79], v[48:51]
    buffer_load_dwordx4 v151, s[28:31], s54 offen offset:1024 lds
    s_add_u32 s54, s54, 16384
    s_waitcnt vmcnt(10) lgkmcnt(0)
    v_mfma_f32_32x32x16_bf16 v[0:15], v[120:123], v[64:67], v[0:15]
    ds_read_b64_tr_b16 v[128:129], v144 offset:10240
    ds_read_b64_tr_b16 v[130:131], v144 offset:10496
    ds_read_b128 v[72:75], v141 offset:49152
    v_mfma_f32_16x16x32_bf16 v[16:19], v[124:127], v[64:67], v[16:19]
    s_mov_b64 exec, s[36:37]
    ds_read_b128 v[132:135], v145 offset:928
    s_mov_b64 exec, -1
    ds_read_b128 v[76:79], v141 offset:57344
    s_add_u32 m0, s49, 8192
    v_mfma_f32_32x32x16_bf16 v[32:47], v[120:123], v[68:71], v[32:47]
    buffer_load_dwordx4 v150, s[28:31], s54 offen offset:0 lds
    v_mfma_f32_16x16x32_bf16 v[48:51], v[124:127], v[68:71], v[48:51]
    buffer_load_dwordx4 v151, s[28:31], s54 offen offset:1024 lds
    s_add_u32 s54, s54, 16384
    s_waitcnt vmcnt(11) lgkmcnt(0)
    v_mfma_f32_32x32x16_bf16 v[0:15], v[128:131], v[72:75], v[0:15]
    ds_read_b64_tr_b16 v[120:121], v144 offset:12288
    ds_read_b64_tr_b16 v[122:123], v144 offset:12544
    ds_read_b128 v[64:67], v142 offset:49152
    v_mfma_f32_16x16x32_bf16 v[16:19], v[132:135], v[72:75], v[16:19]
    s_mov_b64 exec, s[36:37]
    ds_read_b128 v[124:127], v145 offset:960
    s_mov_b64 exec, -1
    ds_read_b128 v[68:71], v142 offset:57344
    s_add_u32 m0, s49, 10240
    v_mfma_f32_32x32x16_bf16 v[32:47], v[128:131], v[76:79], v[32:47]
    buffer_load_dwordx4 v150, s[28:31], s54 offen offset:0 lds
    v_mfma_f32_16x16x32_bf16 v[48:51], v[132:135], v[76:79], v[48:51]
    buffer_load_dwordx4 v151, s[28:31], s54 offen offset:1024 lds
    s_add_u32 s54, s54, 16384
    s_waitcnt vmcnt(12) lgkmcnt(0)
    v_mfma_f32_32x32x16_bf16 v[0:15], v[120:123], v[64:67], v[0:15]
    ds_read_b64_tr_b16 v[128:129], v144 offset:14336
    ds_read_b64_tr_b16 v[130:131], v144 offset:14592
    ds_read_b128 v[72:75], v143 offset:49152
    v_mfma_f32_16x16x32_bf16 v[16:19], v[124:127], v[64:67], v[16:19]
    s_mov_b64 exec, s[36:37]
    ds_read_b128 v[132:135], v145 offset:992
    s_mov_b64 exec, -1
    ds_read_b128 v[76:79], v143 offset:57344
    s_add_u32 m0, s49, 12288
    v_mfma_f32_32x32x16_bf16 v[32:47], v[120:123], v[68:71], v[32:47]
    buffer_load_dwordx4 v150, s[28:31], s54 offen offset:0 lds
    v_mfma_f32_16x16x32_bf16 v[48:51], v[124:127], v[68:71], v[48:51]
    buffer_load_dwordx4 v151, s[28:31], s54 offen offset:1024 lds
    s_add_u32 s54, s7, 114688
    s_waitcnt vmcnt(63) lgkmcnt(0)
    v_mfma_f32_32x32x16_bf16 v[0:15], v[128:131], v[72:75], v[0:15]
    v_mfma_f32_16x16x32_bf16 v[16:19], v[132:135], v[72:75], v[16:19]
    s_add_u32 m0, s49, 14336
    v_mfma_f32_32x32x16_bf16 v[32:47], v[128:131], v[76:79], v[32:47]
    buffer_load_dwordx4 v150, s[16:19], s54 offen offset:0 lds
    s_mov_b64 exec, 1
    ds_add_u32 v177, v167 offset:12
    s_mov_b64 exec, -1
    v_mfma_f32_16x16x32_bf16 v[48:51], v[132:135], v[76:79], v[48:51]
    buffer_load_dwordx4 v151, s[16:19], s54 offen offset:1024 lds
    s_waitcnt vmcnt(28)
L_F1done:
    s_mov_b32 s63, 0
    s_getreg_b32 s61, hwreg(HW_REG_XCC_ID, 0, 4)
    s_setprio 3
    s_branch L_xc_c
L_xc:
    buffer_load_dwordx2 v[194:195], v180, s[44:47], s64 offen sc1
    s_add_u32 s63, s63, 1
    s_cmp_gt_u32 s63, 1000000
    s_cbranch_scc1 L_xc_x
    s_waitcnt vmcnt(0)
L_xc_c:
    v_cmp_ne_u32 vcc, s53, v194
    s_cbranch_vccnz L_xc
L_xc_x:
    v_cmp_ne_u32 vcc, s61, v195
    s_nop 3
    s_cmp_eq_u64 vcc, 0
    s_cselect_b32 s101, 1, 0
    v_max_f32 v0, 0, v0
    v_max_f32 v1, 0, v1
    v_max_f32 v2, 0, v2
    v_max_f32 v3, 0, v3
    v_max_f32 v4, 0, v4
    v_max_f32 v5, 0, v5
    v_max_f32 v6, 0, v6
    v_max_f32 v7, 0, v7
    v_max_f32 v8, 0, v8
    v_max_f32 v9, 0, v9
    v_max_f32 v10, 0, v10
    v_max_f32 v11, 0, v11
    v_max_f32 v12, 0, v12
    v_max_f32 v13, 0, v13
    v_max_f32 v14, 0, v14
    v_max_f32 v15, 0, v15
    v_pk_mul_f32 v[0:1], v[0:1], v[0:1]
    v_pk_mul_f32 v[2:3], v[2:3], v[2:3]
    v_pk_mul_f32 v[4:5], v[4:5], v[4:5]
    v_pk_mul_f32 v[6:7], v[6:7], v[6:7]
    v_pk_mul_f32 v[8:9], v[8:9], v[8:9]
    v_pk_mul_f32 v[10:11], v[10:11], v[10:11]
    v_pk_mul_f32 v[12:13], v[12:13], v[12:13]
    v_pk_mul_f32 v[14:15], v[14:15], v[14:15]
    v_cvt_pk_bf16_f32 v0, v0, v1
    v_cvt_pk_bf16_f32 v1, v2, v3
    v_cvt_pk_bf16_f32 v2, v4, v5
    v_cvt_pk_bf16_f32 v3, v6, v7
    v_cvt_pk_bf16_f32 v4, v8, v9
    v_cvt_pk_bf16_f32 v5, v10, v11
    v_cvt_pk_bf16_f32 v6, v12, v13
    v_cvt_pk_bf16_f32 v7, v14, v15
    s_cmp_eq_u32 s101, 1
    buffer_store_dwordx4 v[0:3], v166, s[44:47], s24 offen offset:0 sc1
    buffer_store_dwordx4 v[4:7], v166, s[44:47], s24 offen offset:1024 sc1
    v_max_f32 v32, 0, v32
    v_max_f32 v33, 0, v33
    v_max_f32 v34, 0, v34
    v_max_f32 v35, 0, v35
    v_max_f32 v36, 0, v36
    v_max_f32 v37, 0, v37
    v_max_f32 v38, 0, v38
    v_max_f32 v39, 0, v39
    v_max_f32 v40, 0, v40
    v_max_f32 v41, 0, v41
    v_max_f32 v42, 0, v42
    v_max_f32 v43, 0, v43
    v_max_f32 v44, 0, v44
    v_max_f32 v45, 0, v45
    v_max_f32 v46, 0, v46
    v_max_f32 v47, 0, v47
    v_pk_mul_f32 v[32:33], v[32:33], v[32:33]
    v_pk_mul_f32 v[34:35], v[34:35], v[34:35]
    v_pk_mul_f32 v[36:37], v[36:37], v[36:37]
    v_pk_mul_f32 v[38:39], v[38:39], v[38:39]
    v_pk_mul_f32 v[40:41], v[40:41], v[40:41]
    v_pk_mul_f32 v[42:43], v[42:43], v[42:43]
    v_pk_mul_f32 v[44:45], v[44:45], v[44:45]
    v_pk_mul_f32 v[46:47], v[46:47], v[46:47]
    v_cvt_pk_bf16_f32 v32, v32, v33
    v_cvt_pk_bf16_f32 v33, v34, v35
    v_cvt_pk_bf16_f32 v34, v36, v37
    v_cvt_pk_bf16_f32 v35, v38, v39
    v_cvt_pk_bf16_f32 v36, v40, v41
    v_cvt_pk_bf16_f32 v37, v42, v43
    v_cvt_pk_bf16_f32 v38, v44, v45
    v_cvt_pk_bf16_f32 v39, v46, v47
    s_cmp_eq_u32 s101, 1
    buffer_store_dwordx4 v[32:35], v166, s[44:47], s25 offen offset:0 sc1
    buffer_store_dwordx4 v[36:39], v166, s[44:47], s25 offen offset:1024 sc1
    s_cmp_eq_u32 s50, 3
    s_cbranch_scc1 L_gate
    v_max_f32 v16, 0, v16
    v_max_f32 v17, 0, v17
    v_max_f32 v18, 0, v18
    v_max_f32 v19, 0, v19
    v_max_f32 v20, 0, v20
    v_max_f32 v21, 0, v21
    v_max_f32 v22, 0, v22
    v_max_f32 v23, 0, v23
    v_max_f32 v24, 0, v24
    v_max_f32 v25, 0, v25
    v_max_f32 v26, 0, v26
    v_max_f32 v27, 0, v27
    v_max_f32 v28, 0, v28
    v_max_f32 v29, 0, v29
    v_max_f32 v30, 0, v30
    v_max_f32 v31, 0, v31
    v_pk_mul_f32 v[16:17], v[16:17], v[16:17]
    v_pk_mul_f32 v[18:19], v[18:19], v[18:19]
    v_pk_mul_f32 v[20:21], v[20:21], v[20:21]
    v_pk_mul_f32 v[22:23], v[22:23], v[22:23]
    v_pk_mul_f32 v[24:25], v[24:25], v[24:25]
    v_pk_mul_f32 v[26:27], v[26:27], v[26:27]
    v_pk_mul_f32 v[28:29], v[28:29], v[28:29]
    v_pk_mul_f32 v[30:31], v[30:31], v[30:31]
    v_cvt_pk_bf16_f32 v16, v16, v17
    v_cvt_pk_bf16_f32 v17, v18, v19
    v_cvt_pk_bf16_f32 v18, v20, v21
    v_cvt_pk_bf16_f32 v19, v22, v23
    v_cvt_pk_bf16_f32 v20, v24, v25
    v_cvt_pk_bf16_f32 v21, v26, v27
    v_cvt_pk_bf16_f32 v22, v28, v29
    v_cvt_pk_bf16_f32 v23, v30, v31
    s_cmp_eq_u32 s101, 1
    buffer_store_dwordx4 v[16:19], v166, s[44:47], s24 offen offset:2048 sc1
    buffer_store_dwordx4 v[20:23], v166, s[44:47], s24 offen offset:3072 sc1
    v_max_f32 v48, 0, v48
    v_max_f32 v49, 0, v49
    v_max_f32 v50, 0, v50
    v_max_f32 v51, 0, v51
    v_max_f32 v52, 0, v52
    v_max_f32 v53, 0, v53
    v_max_f32 v54, 0, v54
    v_max_f32 v55, 0, v55
    v_max_f32 v56, 0, v56
    v_max_f32 v57, 0, v57
    v_max_f32 v58, 0, v58
    v_max_f32 v59, 0, v59
    v_max_f32 v60, 0, v60
    v_max_f32 v61, 0, v61
    v_max_f32 v62, 0, v62
    v_max_f32 v63, 0, v63
    v_pk_mul_f32 v[48:49], v[48:49], v[48:49]
    v_pk_mul_f32 v[50:51], v[50:51], v[50:51]
    v_pk_mul_f32 v[52:53], v[52:53], v[52:53]
    v_pk_mul_f32 v[54:55], v[54:55], v[54:55]
    v_pk_mul_f32 v[56:57], v[56:57], v[56:57]
    v_pk_mul_f32 v[58:59], v[58:59], v[58:59]
    v_pk_mul_f32 v[60:61], v[60:61], v[60:61]
    v_pk_mul_f32 v[62:63], v[62:63], v[62:63]
    v_cvt_pk_bf16_f32 v48, v48, v49
    v_cvt_pk_bf16_f32 v49, v50, v51
    v_cvt_pk_bf16_f32 v50, v52, v53
    v_cvt_pk_bf16_f32 v51, v54, v55
    v_cvt_pk_bf16_f32 v52, v56, v57
    v_cvt_pk_bf16_f32 v53, v58, v59
    v_cvt_pk_bf16_f32 v54, v60, v61
    v_cvt_pk_bf16_f32 v55, v62, v63
    s_cmp_eq_u32 s101, 1
    buffer_store_dwordx4 v[48:51], v166, s[44:47], s25 offen offset:2048 sc1
    buffer_store_dwordx4 v[52:55], v166, s[44:47], s25 offen offset:3072 sc1
    s_branch L_gated
L_gate:
    v_mul_f32 v16, 3216550459, v16
    v_mul_f32 v48, 3216550459, v48
    v_exp_f32 v16, v16
    v_exp_f32 v48, v48
    s_nop 0
    v_add_f32 v16, 1.0, v16
    v_add_f32 v48, 1.0, v48
    v_rcp_f32 v16, v16
    v_rcp_f32 v48, v48
    s_nop 1
    ds_write_b32 v192, v16
    ds_write_b32 v192, v48 offset:128
L_gated:
    s_mov_b64 exec, 1
    ds_add_u32 v177, v167 offset:16
    s_mov_b64 exec, -1
    v_mov_b32 v129, s53
    s_cmp_eq_u32 s101, 1
    s_mov_b64 exec, 1
    s_waitcnt vmcnt(0)
    s_cbranch_scc1 L_hs1a
    buffer_store_dword v129, off, s[44:47], s26 sc1
    s_branch L_hs1b
L_hs1a:
    buffer_store_dword v129, off, s[44:47], s26
L_hs1b:
    s_mov_b64 exec, -1
    s_mov_b32 s63, 0
L_gs1:
    ds_read_b32 v178, v177 offset:16
    s_add_u32 s63, s63, 1
    s_cmp_gt_u32 s63, 1000000
    s_cbranch_scc1 L_gs1_x
    s_waitcnt lgkmcnt(0)
    v_cmp_ne_u32 vcc, 4, v178
    s_cbranch_vccz L_gs1_x
    s_sleep 2
    s_branch L_gs1
L_gs1_x:
    ds_read_b32 v164, v192
    ds_read_b32 v165, v192 offset:128
    s_mov_b32 s63, 0
L_hw:
    buffer_load_dword v178, v180, s[44:47], s27 offen sc1
    s_add_u32 s63, s63, 1
    s_cmp_gt_u32 s63, 1000000
    s_cbranch_scc1 L_hw_x
    s_waitcnt vmcnt(0)
    v_cmp_ne_u32 vcc, s53, v178
    s_cbranch_vccz L_hw_x
    s_sleep 2
    s_branch L_hw
L_hw_x:
    v_mov_b32 v180, v193
    s_setprio 0
    s_mul_i32 s60, s6, 7168
    s_add_u32 s60, s60, s5
    s_add_u32 s61, s60, 114688
    buffer_load_dwordx4 v[64:67], v166, s[44:47], s60 offen sc1
    s_add_u32 s60, s60, 1024
    buffer_load_dwordx4 v[68:71], v166, s[44:47], s61 offen sc1
    s_add_u32 s61, s61, 1024
    buffer_load_dwordx4 v[72:75], v166, s[44:47], s60 offen sc1
    s_add_u32 s60, s60, 1024
    buffer_load_dwordx4 v[76:79], v166, s[44:47], s61 offen sc1
    s_add_u32 s61, s61, 1024
    buffer_load_dwordx4 v[80:83], v166, s[44:47], s60 offen sc1
    s_add_u32 s60, s60, 1024
    buffer_load_dwordx4 v[84:87], v166, s[44:47], s61 offen sc1
    s_add_u32 s61, s61, 1024
    buffer_load_dwordx4 v[88:91], v166, s[44:47], s60 offen sc1
    s_add_u32 s60, s60, 1024
    buffer_load_dwordx4 v[92:95], v166, s[44:47], s61 offen sc1
    s_add_u32 s61, s61, 1024
    buffer_load_dwordx4 v[96:99], v166, s[44:47], s60 offen sc1
    s_add_u32 s60, s60, 1024
    buffer_load_dwordx4 v[100:103], v166, s[44:47], s61 offen sc1
    s_add_u32 s61, s61, 1024
    buffer_load_dwordx4 v[104:107], v166, s[44:47], s60 offen sc1
    s_add_u32 s60, s60, 1024
    buffer_load_dwordx4 v[108:111], v166, s[44:47], s61 offen sc1
    s_add_u32 s61, s61, 1024
    buffer_load_dwordx4 v[112:115], v166, s[44:47], s60 offen sc1
    s_add_u32 s60, s60, 1024
    buffer_load_dwordx4 v[116:119], v166, s[44:47], s61 offen sc1
    s_add_u32 s61, s61, 1024
    ds_read_b64_tr_b16 v[120:121], v146 offset:0
    ds_read_b64_tr_b16 v[122:123], v146 offset:1024
    ds_read_b64_tr_b16 v[124:125], v147 offset:0
    ds_read_b64_tr_b16 v[126:127], v147 offset:1024
    s_add_u32 s6, s6, 1
    s_and_b32 s6, s6, 3
    s_mul_i32 s54, s6, 114688
    s_add_u32 s54, s54, s4
    s_mul_i32 s60, s6, 7168
    s_add_u32 s60, s60, s5
    s_add_u32 s61, s60, 114688
    s_waitcnt vmcnt(12) lgkmcnt(0)
    v_mfma_f32_32x32x16_bf16 v[0:15], v[120:123], v[64:67], 0
    ds_read_b64_tr_b16 v[128:129], v146 offset:2048
    ds_read_b64_tr_b16 v[130:131], v146 offset:3072
    ds_read_b64_tr_b16 v[132:133], v147 offset:2048
    ds_read_b64_tr_b16 v[134:135], v147 offset:3072
    v_mfma_f32_32x32x16_bf16 v[16:31], v[124:127], v[64:67], 0
    buffer_load_dwordx4 v[64:67], v166, s[44:47], s60 offen sc1
    s_add_u32 s60, s60, 1024
    s_add_u32 m0, s49, 0
    v_mfma_f32_32x32x16_bf16 v[32:47], v[120:123], v[68:71], 0
    buffer_load_dwordx4 v150, s[28:31], s54 offen lds
    buffer_load_dwordx4 v151, s[28:31], s54 offen offset:1024 lds
    s_add_u32 s54, s54, 16384
    v_mfma_f32_32x32x16_bf16 v[48:63], v[124:127], v[68:71], 0
    buffer_load_dwordx4 v[68:71], v166, s[44:47], s61 offen sc1
    s_add_u32 s61, s61, 1024
    s_cmp_eq_u32 s50, 3
    s_cbranch_scc0 L_nb2
    v_mfma_f32_32x32x16_bf16 v[0:15], v[168:171], v[160:163], v[0:15]
    v_mfma_f32_32x32x16_bf16 v[16:31], v[172:175], v[160:163], v[16:31]
    v_mfma_f32_32x32x16_bf16 v[32:47], v[168:171], v[160:163], v[32:47]
    v_mfma_f32_32x32x16_bf16 v[48:63], v[172:175], v[160:163], v[48:63]
L_nb2:
    s_waitcnt vmcnt(14) lgkmcnt(0)
    v_mfma_f32_32x32x16_bf16 v[0:15], v[128:131], v[72:75], v[0:15]
    ds_read_b64_tr_b16 v[120:121], v146 offset:4096
    ds_read_b64_tr_b16 v[122:123], v146 offset:5120
    ds_read_b64_tr_b16 v[124:125], v147 offset:4096
    ds_read_b64_tr_b16 v[126:127], v147 offset:5120
    v_mfma_f32_32x32x16_bf16 v[16:31], v[132:135], v[72:75], v[16:31]
    buffer_load_dwordx4 v[72:75], v166, s[44:47], s60 offen sc1
    s_add_u32 s60, s60, 1024
    s_add_u32 m0, s49, 2048
    v_mfma_f32_32x32x16_bf16 v[32:47], v[128:131], v[76:79], v[32:47]
    buffer_load_dwordx4 v150, s[28:31], s54 offen lds
    buffer_load_dwordx4 v151, s[28:31], s54 offen offset:1024 lds
    s_add_u32 s54, s54, 16384
    v_mfma_f32_32x32x16_bf16 v[48:63], v[132:135], v[76:79], v[48:63]
    buffer_load_dwordx4 v[76:79], v166, s[44:47], s61 offen sc1
    s_add_u32 s61, s61, 1024
    s_waitcnt vmcnt(16) lgkmcnt(0)
    v_mfma_f32_32x32x16_bf16 v[0:15], v[120:123], v[80:83], v[0:15]
    ds_read_b64_tr_b16 v[128:129], v146 offset:6144
    ds_read_b64_tr_b16 v[130:131], v146 offset:7168
    ds_read_b64_tr_b16 v[132:133], v147 offset:6144
    ds_read_b64_tr_b16 v[134:135], v147 offset:7168
    v_mfma_f32_32x32x16_bf16 v[16:31], v[124:127], v[80:83], v[16:31]
    buffer_load_dwordx4 v[80:83], v166, s[44:47], s60 offen sc1
    s_add_u32 s60, s60, 1024
    s_add_u32 m0, s49, 4096
    v_mfma_f32_32x32x16_bf16 v[32:47], v[120:123], v[84:87], v[32:47]
    buffer_load_dwordx4 v150, s[28:31], s54 offen lds
    buffer_load_dwordx4 v151, s[28:31], s54 offen offset:1024 lds
    s_add_u32 s54, s54, 16384
    v_mfma_f32_32x32x16_bf16 v[48:63], v[124:127], v[84:87], v[48:63]
    buffer_load_dwordx4 v[84:87], v166, s[44:47], s61 offen sc1
    s_add_u32 s61, s61, 1024
    s_waitcnt vmcnt(18) lgkmcnt(0)
    v_mfma_f32_32x32x16_bf16 v[0:15], v[128:131], v[88:91], v[0:15]
    ds_read_b64_tr_b16 v[120:121], v146 offset:8192
    ds_read_b64_tr_b16 v[122:123], v146 offset:9216
    ds_read_b64_tr_b16 v[124:125], v147 offset:8192
    ds_read_b64_tr_b16 v[126:127], v147 offset:9216
    v_mfma_f32_32x32x16_bf16 v[16:31], v[132:135], v[88:91], v[16:31]
    buffer_load_dwordx4 v[88:91], v166, s[44:47], s60 offen sc1
    s_add_u32 s60, s60, 1024
    s_add_u32 m0, s49, 6144
    v_mfma_f32_32x32x16_bf16 v[32:47], v[128:131], v[92:95], v[32:47]
    buffer_load_dwordx4 v150, s[28:31], s54 offen lds
    buffer_load_dwordx4 v151, s[28:31], s54 offen offset:1024 lds
    s_add_u32 s54, s54, 16384
    v_mfma_f32_32x32x16_bf16 v[48:63], v[132:135], v[92:95], v[48:63]
    buffer_load_dwordx4 v[92:95], v166, s[44:47], s61 offen sc1
    s_add_u32 s61, s61, 1024
    s_waitcnt vmcnt(20) lgkmcnt(0)
    v_mfma_f32_32x32x16_bf16 v[0:15], v[120:123], v[96:99], v[0:15]
    ds_read_b64_tr_b16 v[128:129], v146 offset:10240
    ds_read_b64_tr_b16 v[130:131], v146 offset:11264
    ds_read_b64_tr_b16 v[132:133], v147 offset:10240
    ds_read_b64_tr_b16 v[134:135], v147 offset:11264
    v_mfma_f32_32x32x16_bf16 v[16:31], v[124:127], v[96:99], v[16:31]
    buffer_load_dwordx4 v[96:99], v166, s[44:47], s60 offen sc1
    s_add_u32 s60, s60, 1024
    s_add_u32 m0, s49, 8192
    v_mfma_f32_32x32x16_bf16 v[32:47], v[120:123], v[100:103], v[32:47]
    buffer_load_dwordx4 v150, s[28:31], s54 offen lds
    buffer_load_dwordx4 v151, s[28:31], s54 offen offset:1024 lds
    s_add_u32 s54, s54, 16384
    v_mfma_f32_32x32x16_bf16 v[48:63], v[124:127], v[100:103], v[48:63]
    buffer_load_dwordx4 v[100:103], v166, s[44:47], s61 offen sc1
    s_add_u32 s61, s61, 1024
    s_waitcnt vmcnt(22) lgkmcnt(0)
    v_mfma_f32_32x32x16_bf16 v[0:15], v[128:131], v[104:107], v[0:15]
    ds_read_b64_tr_b16 v[120:121], v146 offset:12288
    ds_read_b64_tr_b16 v[122:123], v146 offset:13312
    ds_read_b64_tr_b16 v[124:125], v147 offset:12288
    ds_read_b64_tr_b16 v[126:127], v147 offset:13312
    v_mfma_f32_32x32x16_bf16 v[16:31], v[132:135], v[104:107], v[16:31]
    buffer_load_dwordx4 v[104:107], v166, s[44:47], s60 offen sc1
    s_add_u32 s60, s60, 1024
    s_add_u32 m0, s49, 10240
    v_mfma_f32_32x32x16_bf16 v[32:47], v[128:131], v[108:111], v[32:47]
    buffer_load_dwordx4 v150, s[28:31], s54 offen lds
    buffer_load_dwordx4 v151, s[28:31], s54 offen offset:1024 lds
    s_add_u32 s54, s54, 16384
    v_mfma_f32_32x32x16_bf16 v[48:63], v[132:135], v[108:111], v[48:63]
    buffer_load_dwordx4 v[108:111], v166, s[44:47], s61 offen sc1
    s_add_u32 s61, s61, 1024
    s_waitcnt vmcnt(21) lgkmcnt(0)
    v_mfma_f32_32x32x16_bf16 v[0:15], v[120:123], v[112:115], v[0:15]
    ds_read_b64_tr_b16 v[128:129], v146 offset:0
    ds_read_b64_tr_b16 v[130:131], v146 offset:1024
    ds_read_b64_tr_b16 v[132:133], v147 offset:0
    ds_read_b64_tr_b16 v[134:135], v147 offset:1024
    v_mfma_f32_32x32x16_bf16 v[16:31], v[124:127], v[112:115], v[16:31]
    buffer_load_dwordx4 v[112:115], v166, s[44:47], s60 offen sc1
    s_add_u32 s60, s60, 1024
    s_add_u32 m0, s49, 12288
    v_mfma_f32_32x32x16_bf16 v[32:47], v[120:123], v[116:119], v[32:47]
    buffer_load_dwordx4 v150, s[28:31], s54 offen lds
    buffer_load_dwordx4 v151, s[28:31], s54 offen offset:1024 lds
    s_add_u32 s54, s54, 16384
    v_mfma_f32_32x32x16_bf16 v[48:63], v[124:127], v[116:119], v[48:63]
    buffer_load_dwordx4 v[116:119], v166, s[44:47], s61 offen sc1
    s_add_u32 s61, s61, 1024
    s_add_u32 s6, s6, 1
    s_and_b32 s6, s6, 3
    s_mul_i32 s54, s6, 114688
    s_add_u32 s54, s54, s4
    s_mul_i32 s60, s6, 7168
    s_add_u32 s60, s60, s5
    s_add_u32 s61, s60, 114688
    s_waitcnt vmcnt(21) lgkmcnt(0)
    v_mfma_f32_32x32x16_bf16 v[0:15], v[128:131], v[64:67], v[0:15]
    ds_read_b64_tr_b16 v[120:121], v146 offset:2048
    ds_read_b64_tr_b16 v[122:123], v146 offset:3072
    ds_read_b64_tr_b16 v[124:125], v147 offset:2048
    ds_read_b64_tr_b16 v[126:127], v147 offset:3072
    v_mfma_f32_32x32x16_bf16 v[16:31], v[132:135], v[64:67], v[16:31]
    buffer_load_dwordx4 v[64:67], v166, s[44:47], s60 offen sc1
    s_add_u32 s60, s60, 1024
    s_add_u32 m0, s49, 0
    v_mfma_f32_32x32x16_bf16 v[32:47], v[128:131], v[68:71], v[32:47]
    buffer_load_dwordx4 v150, s[28:31], s54 offen lds
    buffer_load_dwordx4 v151, s[28:31], s54 offen offset:1024 lds
    s_add_u32 s54, s54, 16384
    v_mfma_f32_32x32x16_bf16 v[48:63], v[132:135], v[68:71], v[48:63]
    buffer_load_dwordx4 v[68:71], v166, s[44:47], s61 offen sc1
    s_add_u32 s61, s61, 1024
    s_waitcnt vmcnt(21) lgkmcnt(0)
    v_mfma_f32_32x32x16_bf16 v[0:15], v[120:123], v[72:75], v[0:15]
    ds_read_b64_tr_b16 v[128:129], v146 offset:4096
    ds_read_b64_tr_b16 v[130:131], v146 offset:5120
    ds_read_b64_tr_b16 v[132:133], v147 offset:4096
    ds_read_b64_tr_b16 v[134:135], v147 offset:5120
    v_mfma_f32_32x32x16_bf16 v[16:31], v[124:127], v[72:75], v[16:31]
    buffer_load_dwordx4 v[72:75], v166, s[44:47], s60 offen sc1
    s_add_u32 s60, s60, 1024
    s_add_u32 m0, s49, 2048
    v_mfma_f32_32x32x16_bf16 v[32:47], v[120:123], v[76:79], v[32:47]
    buffer_load_dwordx4 v150, s[28:31], s54 offen lds
    buffer_load_dwordx4 v151, s[28:31], s54 offen offset:1024 lds
    s_add_u32 s54, s54, 16384
    v_mfma_f32_32x32x16_bf16 v[48:63], v[124:127], v[76:79], v[48:63]
    buffer_load_dwordx4 v[76:79], v166, s[44:47], s61 offen sc1
    s_add_u32 s61, s61, 1024
    s_waitcnt vmcnt(21) lgkmcnt(0)
    v_mfma_f32_32x32x16_bf16 v[0:15], v[128:131], v[80:83], v[0:15]
    ds_read_b64_tr_b16 v[120:121], v146 offset:6144
    ds_read_b64_tr_b16 v[122:123], v146 offset:7168
    ds_read_b64_tr_b16 v[124:125], v147 offset:6144
    ds_read_b64_tr_b16 v[126:127], v147 offset:7168
    v_mfma_f32_32x32x16_bf16 v[16:31], v[132:135], v[80:83], v[16:31]
    buffer_load_dwordx4 v[80:83], v166, s[44:47], s60 offen sc1
    s_add_u32 s60, s60, 1024
    s_add_u32 m0, s49, 4096
    v_mfma_f32_32x32x16_bf16 v[32:47], v[128:131], v[84:87], v[32:47]
    buffer_load_dwordx4 v150, s[28:31], s54 offen lds
    buffer_load_dwordx4 v151, s[28:31], s54 offen offset:1024 lds
    s_add_u32 s54, s54, 16384
    v_mfma_f32_32x32x16_bf16 v[48:63], v[132:135], v[84:87], v[48:63]
    buffer_load_dwordx4 v[84:87], v166, s[44:47], s61 offen sc1
    s_add_u32 s61, s61, 1024
    s_waitcnt vmcnt(21) lgkmcnt(0)
    v_mfma_f32_32x32x16_bf16 v[0:15], v[120:123], v[88:91], v[0:15]
    ds_read_b64_tr_b16 v[128:129], v146 offset:8192
    ds_read_b64_tr_b16 v[130:131], v146 offset:9216
    ds_read_b64_tr_b16 v[132:133], v147 offset:8192
    ds_read_b64_tr_b16 v[134:135], v147 offset:9216
    v_mfma_f32_32x32x16_bf16 v[16:31], v[124:127], v[88:91], v[16:31]
    buffer_load_dwordx4 v[88:91], v166, s[44:47], s60 offen sc1
    s_add_u32 s60, s60, 1024
    s_add_u32 m0, s49, 6144
    v_mfma_f32_32x32x16_bf16 v[32:47], v[120:123], v[92:95], v[32:47]
    buffer_load_dwordx4 v150, s[28:31], s54 offen lds
    buffer_load_dwordx4 v151, s[28:31], s54 offen offset:1024 lds
    s_add_u32 s54, s54, 16384
    v_mfma_f32_32x32x16_bf16 v[48:63], v[124:127], v[92:95], v[48:63]
    buffer_load_dwordx4 v[92:95], v166, s[44:47], s61 offen sc1
    s_add_u32 s61, s61, 1024
    s_waitcnt vmcnt(21) lgkmcnt(0)
    v_mfma_f32_32x32x16_bf16 v[0:15], v[128:131], v[96:99], v[0:15]
    ds_read_b64_tr_b16 v[120:121], v146 offset:10240
    ds_read_b64_tr_b16 v[122:123], v146 offset:11264
    ds_read_b64_tr_b16 v[124:125], v147 offset:10240
    ds_read_b64_tr_b16 v[126:127], v147 offset:11264
    v_mfma_f32_32x32x16_bf16 v[16:31], v[132:135], v[96:99], v[16:31]
    buffer_load_dwordx4 v[96:99], v166, s[44:47], s60 offen sc1
    s_add_u32 s60, s60, 1024
    s_add_u32 m0, s49, 8192
    v_mfma_f32_32x32x16_bf16 v[32:47], v[128:131], v[100:103], v[32:47]
    buffer_load_dwordx4 v150, s[28:31], s54 offen lds
    buffer_load_dwordx4 v151, s[28:31], s54 offen offset:1024 lds
    s_add_u32 s54, s54, 16384
    v_mfma_f32_32x32x16_bf16 v[48:63], v[132:135], v[100:103], v[48:63]
    buffer_load_dwordx4 v[100:103], v166, s[44:47], s61 offen sc1
    s_add_u32 s61, s61, 1024
    s_waitcnt vmcnt(21) lgkmcnt(0)
    v_mfma_f32_32x32x16_bf16 v[0:15], v[120:123], v[104:107], v[0:15]
    ds_read_b64_tr_b16 v[128:129], v146 offset:12288
    ds_read_b64_tr_b16 v[130:131], v146 offset:13312
    ds_read_b64_tr_b16 v[132:133], v147 offset:12288
    ds_read_b64_tr_b16 v[134:135], v147 offset:13312
    v_mfma_f32_32x32x16_bf16 v[16:31], v[124:127], v[104:107], v[16:31]
    buffer_load_dwordx4 v[104:107], v166, s[44:47], s60 offen sc1
    s_add_u32 s60, s60, 1024
    s_add_u32 m0, s49, 10240
    v_mfma_f32_32x32x16_bf16 v[32:47], v[120:123], v[108:111], v[32:47]
    buffer_load_dwordx4 v150, s[28:31], s54 offen lds
    buffer_load_dwordx4 v151, s[28:31], s54 offen offset:1024 lds
    s_add_u32 s54, s54, 16384
    v_mfma_f32_32x32x16_bf16 v[48:63], v[124:127], v[108:111], v[48:63]
    buffer_load_dwordx4 v[108:111], v166, s[44:47], s61 offen sc1
    s_add_u32 s61, s61, 1024
    s_waitcnt vmcnt(21) lgkmcnt(0)
    v_mfma_f32_32x32x16_bf16 v[0:15], v[128:131], v[112:115], v[0:15]
    ds_read_b64_tr_b16 v[120:121], v146 offset:0
    ds_read_b64_tr_b16 v[122:123], v146 offset:1024
    ds_read_b64_tr_b16 v[124:125], v147 offset:0
    ds_read_b64_tr_b16 v[126:127], v147 offset:1024
    v_mfma_f32_32x32x16_bf16 v[16:31], v[132:135], v[112:115], v[16:31]
    buffer_load_dwordx4 v[112:115], v166, s[44:47], s60 offen sc1
    s_add_u32 s60, s60, 1024
    s_add_u32 m0, s49, 12288
    v_mfma_f32_32x32x16_bf16 v[32:47], v[128:131], v[116:119], v[32:47]
    buffer_load_dwordx4 v150, s[28:31], s54 offen lds
    buffer_load_dwordx4 v151, s[28:31], s54 offen offset:1024 lds
    s_add_u32 s54, s54, 16384
    v_mfma_f32_32x32x16_bf16 v[48:63], v[132:135], v[116:119], v[48:63]
    buffer_load_dwordx4 v[116:119], v166, s[44:47], s61 offen sc1
    s_add_u32 s61, s61, 1024
    s_add_u32 s6, s6, 1
    s_and_b32 s6, s6, 3
    s_mul_i32 s54, s6, 114688
    s_add_u32 s54, s54, s4
    s_mul_i32 s60, s6, 7168
    s_add_u32 s60, s60, s5
    s_add_u32 s61, s60, 114688
    s_waitcnt vmcnt(21) lgkmcnt(0)
    v_mfma_f32_32x32x16_bf16 v[0:15], v[120:123], v[64:67], v[0:15]
    ds_read_b64_tr_b16 v[128:129], v146 offset:2048
    ds_read_b64_tr_b16 v[130:131], v146 offset:3072
    ds_read_b64_tr_b16 v[132:133], v147 offset:2048
    ds_read_b64_tr_b16 v[134:135], v147 offset:3072
    v_mfma_f32_32x32x16_bf16 v[16:31], v[124:127], v[64:67], v[16:31]
    buffer_load_dwordx4 v[64:67], v166, s[44:47], s60 offen sc1
    s_add_u32 s60, s60, 1024
    s_add_u32 m0, s49, 0
    v_mfma_f32_32x32x16_bf16 v[32:47], v[120:123], v[68:71], v[32:47]
    buffer_load_dwordx4 v150, s[28:31], s54 offen lds
    buffer_load_dwordx4 v151, s[28:31], s54 offen offset:1024 lds
    s_add_u32 s54, s54, 16384
    v_mfma_f32_32x32x16_bf16 v[48:63], v[124:127], v[68:71], v[48:63]
    buffer_load_dwordx4 v[68:71], v166, s[44:47], s61 offen sc1
    s_add_u32 s61, s61, 1024
    s_waitcnt vmcnt(21) lgkmcnt(0)
    v_mfma_f32_32x32x16_bf16 v[0:15], v[128:131], v[72:75], v[0:15]
    ds_read_b64_tr_b16 v[120:121], v146 offset:4096
    ds_read_b64_tr_b16 v[122:123], v146 offset:5120
    ds_read_b64_tr_b16 v[124:125], v147 offset:4096
    ds_read_b64_tr_b16 v[126:127], v147 offset:5120
    v_mfma_f32_32x32x16_bf16 v[16:31], v[132:135], v[72:75], v[16:31]
    buffer_load_dwordx4 v[72:75], v166, s[44:47], s60 offen sc1
    s_add_u32 s60, s60, 1024
    s_add_u32 m0, s49, 2048
    v_mfma_f32_32x32x16_bf16 v[32:47], v[128:131], v[76:79], v[32:47]
    buffer_load_dwordx4 v150, s[28:31], s54 offen lds
    buffer_load_dwordx4 v151, s[28:31], s54 offen offset:1024 lds
    s_add_u32 s54, s54, 16384
    v_mfma_f32_32x32x16_bf16 v[48:63], v[132:135], v[76:79], v[48:63]
    buffer_load_dwordx4 v[76:79], v166, s[44:47], s61 offen sc1
    s_add_u32 s61, s61, 1024
    s_setprio 3
    v_subrev_u32 v168, 131072, v190
    v_subrev_u32 v169, 131072, v191
    v_mov_b32 v170, v198
    s_mov_b32 s63, 0
L_fwm:
    ds_read_b32 v196, v176
    s_add_u32 s63, s63, 1
    s_cmp_gt_u32 s63, 1000000
    s_cbranch_scc1 L_fwm_x
    s_waitcnt lgkmcnt(0)
    v_cmp_ne_u32 vcc, s53, v196
    s_cbranch_vccz L_fwm_x
    s_sleep 3
    s_branch L_fwm
L_fwm_x:
    ds_read2st64_b32 v[228:229], v181 offset0:32 offset1:33
    ds_read2st64_b32 v[230:231], v181 offset0:34 offset1:35
    ds_read2st64_b32 v[196:197], v181 offset0:0 offset1:4
    ds_read2st64_b32 v[198:199], v181 offset0:8 offset1:12
    ds_read2st64_b32 v[200:201], v181 offset0:16 offset1:20
    ds_read2st64_b32 v[202:203], v181 offset0:24 offset1:28
    ds_read2st64_b32 v[204:205], v181 offset0:1 offset1:5
    ds_read2st64_b32 v[206:207], v181 offset0:9 offset1:13
    ds_read2st64_b32 v[208:209], v181 offset0:17 offset1:21
    ds_read2st64_b32 v[210:211], v181 offset0:25 offset1:29
    ds_read2st64_b32 v[212:213], v181 offset0:2 offset1:6
    ds_read2st64_b32 v[214:215], v181 offset0:10 offset1:14
    ds_read2st64_b32 v[216:217], v181 offset0:18 offset1:22
    ds_read2st64_b32 v[218:219], v181 offset0:26 offset1:30
    ds_read2st64_b32 v[220:221], v181 offset0:3 offset1:7
    ds_read2st64_b32 v[222:223], v181 offset0:11 offset1:15
    ds_read2st64_b32 v[224:225], v181 offset0:19 offset1:23
    ds_read2st64_b32 v[226:227], v181 offset0:27 offset1:31
    s_cmp_eq_u32 s58, 1
    s_waitcnt lgkmcnt(8)
    v_pk_add_f32 v[228:229], v[228:229], v[230:231]
    v_pk_add_f32 v[196:197], v[196:197], v[204:205]
    v_pk_add_f32 v[198:199], v[198:199], v[206:207]
    v_pk_add_f32 v[200:201], v[200:201], v[208:209]
    v_pk_add_f32 v[202:203], v[202:203], v[210:211]
    v_add_f32 v228, v228, v229
    s_waitcnt lgkmcnt(0)
    v_pk_add_f32 v[212:213], v[212:213], v[220:221]
    v_pk_add_f32 v[214:215], v[214:215], v[222:223]
    v_pk_add_f32 v[216:217], v[216:217], v[224:225]
    v_pk_add_f32 v[218:219], v[218:219], v[226:227]
    v_rcp_f32 v228, v228
    v_pk_add_f32 v[196:197], v[196:197], v[212:213]
    v_pk_add_f32 v[198:199], v[198:199], v[214:215]
    v_pk_add_f32 v[200:201], v[200:201], v[216:217]
    v_pk_add_f32 v[202:203], v[202:203], v[218:219]
    v_mul_f32 v228, v228, v164
    v_pk_mul_f32 v[196:197], v[196:197], v[228:229] op_sel_hi:[1,0]
    v_pk_mul_f32 v[198:199], v[198:199], v[228:229] op_sel_hi:[1,0]
    v_pk_mul_f32 v[200:201], v[200:201], v[228:229] op_sel_hi:[1,0]
    v_pk_mul_f32 v[202:203], v[202:203], v[228:229] op_sel_hi:[1,0]
    v_cvt_pk_bf16_f32 v196, v196, v197
    v_cvt_pk_bf16_f32 v197, v198, v199
    v_cvt_pk_bf16_f32 v198, v200, v201
    v_cvt_pk_bf16_f32 v199, v202, v203
    v_min_u32 v196, -2, v196
    v_min_u32 v197, -2, v197
    v_min_u32 v198, -2, v198
    v_min_u32 v199, -2, v199
    buffer_store_dwordx4 v[196:199], v166, s[44:47], s8 offen sc1
    s_or_b32 s55, s2, s50
    s_cbranch_scc1 L_noep
    v_mov_b32 v229, s53
    s_mov_b64 exec, 1
    buffer_store_dword v229, off, s[44:47], 0 sc1
    s_mov_b64 exec, -1
L_noep:
    s_setprio 0
    s_waitcnt vmcnt(21) lgkmcnt(0)
    v_mfma_f32_32x32x16_bf16 v[0:15], v[120:123], v[80:83], v[0:15]
    ds_read_b64_tr_b16 v[128:129], v146 offset:6144
    ds_read_b64_tr_b16 v[130:131], v146 offset:7168
    ds_read_b64_tr_b16 v[132:133], v147 offset:6144
    ds_read_b64_tr_b16 v[134:135], v147 offset:7168
    v_mfma_f32_32x32x16_bf16 v[16:31], v[124:127], v[80:83], v[16:31]
    buffer_load_dwordx4 v[80:83], v166, s[44:47], s60 offen sc1
    s_add_u32 s60, s60, 1024
    s_add_u32 m0, s49, 4096
    v_mfma_f32_32x32x16_bf16 v[32:47], v[120:123], v[84:87], v[32:47]
    buffer_load_dwordx4 v150, s[28:31], s54 offen lds
    buffer_load_dwordx4 v151, s[28:31], s54 offen offset:1024 lds
    s_add_u32 s54, s54, 16384
    v_mfma_f32_32x32x16_bf16 v[48:63], v[124:127], v[84:87], v[48:63]
    buffer_load_dwordx4 v[84:87], v166, s[44:47], s61 offen sc1
    s_add_u32 s61, s61, 1024
    s_waitcnt vmcnt(21) lgkmcnt(0)
    v_mfma_f32_32x32x16_bf16 v[0:15], v[128:131], v[88:91], v[0:15]
    ds_read_b64_tr_b16 v[120:121], v146 offset:8192
    ds_read_b64_tr_b16 v[122:123], v146 offset:9216
    ds_read_b64_tr_b16 v[124:125], v147 offset:8192
    ds_read_b64_tr_b16 v[126:127], v147 offset:9216
    v_mfma_f32_32x32x16_bf16 v[16:31], v[132:135], v[88:91], v[16:31]
    buffer_load_dwordx4 v[88:91], v166, s[44:47], s60 offen sc1
    s_add_u32 s60, s60, 1024
    s_add_u32 m0, s49, 6144
    v_mfma_f32_32x32x16_bf16 v[32:47], v[128:131], v[92:95], v[32:47]
    buffer_load_dwordx4 v150, s[28:31], s54 offen lds
    buffer_load_dwordx4 v151, s[28:31], s54 offen offset:1024 lds
    s_add_u32 s54, s54, 16384
    v_mfma_f32_32x32x16_bf16 v[48:63], v[132:135], v[92:95], v[48:63]
    buffer_load_dwordx4 v[92:95], v166, s[44:47], s61 offen sc1
    s_add_u32 s61, s61, 1024
    s_waitcnt vmcnt(21) lgkmcnt(0)
    v_mfma_f32_32x32x16_bf16 v[0:15], v[120:123], v[96:99], v[0:15]
    ds_read_b64_tr_b16 v[128:129], v146 offset:10240
    ds_read_b64_tr_b16 v[130:131], v146 offset:11264
    ds_read_b64_tr_b16 v[132:133], v147 offset:10240
    ds_read_b64_tr_b16 v[134:135], v147 offset:11264
    v_mfma_f32_32x32x16_bf16 v[16:31], v[124:127], v[96:99], v[16:31]
    buffer_load_dwordx4 v[96:99], v166, s[44:47], s60 offen sc1
    s_add_u32 s60, s60, 1024
    s_add_u32 m0, s49, 8192
    v_mfma_f32_32x32x16_bf16 v[32:47], v[120:123], v[100:103], v[32:47]
    buffer_load_dwordx4 v150, s[28:31], s54 offen lds
    buffer_load_dwordx4 v151, s[28:31], s54 offen offset:1024 lds
    s_add_u32 s54, s54, 16384
    v_mfma_f32_32x32x16_bf16 v[48:63], v[124:127], v[100:103], v[48:63]
    buffer_load_dwordx4 v[100:103], v166, s[44:47], s61 offen sc1
    s_add_u32 s61, s61, 1024
    s_waitcnt vmcnt(21) lgkmcnt(0)
    v_mfma_f32_32x32x16_bf16 v[0:15], v[128:131], v[104:107], v[0:15]
    ds_read_b64_tr_b16 v[120:121], v146 offset:12288
    ds_read_b64_tr_b16 v[122:123], v146 offset:13312
    ds_read_b64_tr_b16 v[124:125], v147 offset:12288
    ds_read_b64_tr_b16 v[126:127], v147 offset:13312
    v_mfma_f32_32x32x16_bf16 v[16:31], v[132:135], v[104:107], v[16:31]
    buffer_load_dwordx4 v[104:107], v166, s[44:47], s60 offen sc1
    s_add_u32 s60, s60, 1024
    s_add_u32 m0, s49, 10240
    v_mfma_f32_32x32x16_bf16 v[32:47], v[128:131], v[108:111], v[32:47]
    buffer_load_dwordx4 v150, s[28:31], s54 offen lds
    buffer_load_dwordx4 v151, s[28:31], s54 offen offset:1024 lds
    s_add_u32 s54, s54, 16384
    v_mfma_f32_32x32x16_bf16 v[48:63], v[132:135], v[108:111], v[48:63]
    buffer_load_dwordx4 v[108:111], v166, s[44:47], s61 offen sc1
    s_add_u32 s61, s61, 1024
    s_waitcnt vmcnt(21) lgkmcnt(0)
    v_mfma_f32_32x32x16_bf16 v[0:15], v[120:123], v[112:115], v[0:15]
    ds_read_b64_tr_b16 v[128:129], v146 offset:0
    ds_read_b64_tr_b16 v[130:131], v146 offset:1024
    ds_read_b64_tr_b16 v[132:133], v147 offset:0
    ds_read_b64_tr_b16 v[134:135], v147 offset:1024
    v_mfma_f32_32x32x16_bf16 v[16:31], v[124:127], v[112:115], v[16:31]
    buffer_load_dwordx4 v[112:115], v166, s[44:47], s60 offen sc1
    s_add_u32 s60, s60, 1024
    s_add_u32 m0, s49, 12288
    v_mfma_f32_32x32x16_bf16 v[32:47], v[120:123], v[116:119], v[32:47]
    buffer_load_dwordx4 v150, s[28:31], s54 offen lds
    buffer_load_dwordx4 v151, s[28:31], s54 offen offset:1024 lds
    s_add_u32 s54, s54, 16384
    v_mfma_f32_32x32x16_bf16 v[48:63], v[124:127], v[116:119], v[48:63]
    buffer_load_dwordx4 v[116:119], v166, s[44:47], s61 offen sc1
    s_add_u32 s61, s61, 1024
    s_mov_b32 s54, s7
    s_mov_b32 s60, s10
    s_mov_b32 s61, s65
    s_waitcnt vmcnt(21) lgkmcnt(0)
    v_mfma_f32_32x32x16_bf16 v[0:15], v[128:131], v[64:67], v[0:15]
    ds_read_b64_tr_b16 v[120:121], v146 offset:2048
    ds_read_b64_tr_b16 v[122:123], v146 offset:3072
    ds_read_b64_tr_b16 v[124:125], v147 offset:2048
    ds_read_b64_tr_b16 v[126:127], v147 offset:3072
    v_mfma_f32_32x32x16_bf16 v[16:31], v[132:135], v[64:67], v[16:31]
    buffer_load_dwordx4 v[64:67], v166, s[44:47], s60 offen sc1
    s_add_u32 s60, s60, 1024
    s_add_u32 m0, s49, 0
    v_mfma_f32_32x32x16_bf16 v[32:47], v[128:131], v[68:71], v[32:47]
    buffer_load_dwordx4 v150, s[16:19], s54 offen lds
    buffer_load_dwordx4 v151, s[16:19], s54 offen offset:1024 lds
    s_add_u32 s54, s54, 16384
    v_mfma_f32_32x32x16_bf16 v[48:63], v[132:135], v[68:71], v[48:63]
    buffer_load_dwordx4 v[68:71], v166, s[44:47], s61 offen sc1
    s_add_u32 s61, s61, 1024
    s_waitcnt vmcnt(21) lgkmcnt(0)
    v_mfma_f32_32x32x16_bf16 v[0:15], v[120:123], v[72:75], v[0:15]
    ds_read_b64_tr_b16 v[128:129], v146 offset:4096
    ds_read_b64_tr_b16 v[130:131], v146 offset:5120
    ds_read_b64_tr_b16 v[132:133], v147 offset:4096
    ds_read_b64_tr_b16 v[134:135], v147 offset:5120
    v_mfma_f32_32x32x16_bf16 v[16:31], v[124:127], v[72:75], v[16:31]
    buffer_load_dwordx4 v[72:75], v166, s[44:47], s60 offen sc1
    s_add_u32 s60, s60, 1024
    s_add_u32 m0, s49, 2048
    v_mfma_f32_32x32x16_bf16 v[32:47], v[120:123], v[76:79], v[32:47]
    buffer_load_dwordx4 v150, s[16:19], s54 offen lds
    buffer_load_dwordx4 v151, s[16:19], s54 offen offset:1024 lds
    s_add_u32 s54, s54, 16384
    v_mfma_f32_32x32x16_bf16 v[48:63], v[124:127], v[76:79], v[48:63]
    buffer_load_dwordx4 v[76:79], v166, s[44:47], s61 offen sc1
    s_add_u32 s61, s61, 1024
    s_waitcnt vmcnt(21) lgkmcnt(0)
    v_mfma_f32_32x32x16_bf16 v[0:15], v[128:131], v[80:83], v[0:15]
    ds_read_b64_tr_b16 v[120:121], v146 offset:6144
    ds_read_b64_tr_b16 v[122:123], v146 offset:7168
    ds_read_b64_tr_b16 v[124:125], v147 offset:6144
    ds_read_b64_tr_b16 v[126:127], v147 offset:7168
    v_mfma_f32_32x32x16_bf16 v[16:31], v[132:135], v[80:83], v[16:31]
    buffer_load_dwordx4 v[80:83], v166, s[44:47], s60 offen sc1
    s_add_u32 s60, s60, 1024
    s_add_u32 m0, s49, 4096
    v_mfma_f32_32x32x16_bf16 v[32:47], v[128:131], v[84:87], v[32:47]
    buffer_load_dwordx4 v150, s[16:19], s54 offen lds
    buffer_load_dwordx4 v151, s[16:19], s54 offen offset:1024 lds
    s_add_u32 s54, s54, 16384
    v_mfma_f32_32x32x16_bf16 v[48:63], v[132:135], v[84:87], v[48:63]
    buffer_load_dwordx4 v[84:87], v166, s[44:47], s61 offen sc1
    s_add_u32 s61, s61, 1024
    s_waitcnt vmcnt(21) lgkmcnt(0)
    v_mfma_f32_32x32x16_bf16 v[0:15], v[120:123], v[88:91], v[0:15]
    ds_read_b64_tr_b16 v[128:129], v146 offset:8192
    ds_read_b64_tr_b16 v[130:131], v146 offset:9216
    ds_read_b64_tr_b16 v[132:133], v147 offset:8192
    ds_read_b64_tr_b16 v[134:135], v147 offset:9216
    v_mfma_f32_32x32x16_bf16 v[16:31], v[124:127], v[88:91], v[16:31]
    buffer_load_dwordx4 v[88:91], v166, s[44:47], s60 offen sc1
    s_add_u32 s60, s60, 1024
    s_add_u32 m0, s49, 6144
    v_mfma_f32_32x32x16_bf16 v[32:47], v[120:123], v[92:95], v[32:47]
    buffer_load_dwordx4 v150, s[16:19], s54 offen lds
    buffer_load_dwordx4 v151, s[16:19], s54 offen offset:1024 lds
    s_add_u32 s54, s54, 16384
    v_mfma_f32_32x32x16_bf16 v[48:63], v[124:127], v[92:95], v[48:63]
    buffer_load_dwordx4 v[92:95], v166, s[44:47], s61 offen sc1
    s_add_u32 s61, s61, 1024
    s_waitcnt vmcnt(21) lgkmcnt(0)
    v_mfma_f32_32x32x16_bf16 v[0:15], v[128:131], v[96:99], v[0:15]
    ds_read_b64_tr_b16 v[120:121], v146 offset:10240
    ds_read_b64_tr_b16 v[122:123], v146 offset:11264
    ds_read_b64_tr_b16 v[124:125], v147 offset:10240
    ds_read_b64_tr_b16 v[126:127], v147 offset:11264
    v_mfma_f32_32x32x16_bf16 v[16:31], v[132:135], v[96:99], v[16:31]
    s_add_u32 m0, s49, 8192
    v_mfma_f32_32x32x16_bf16 v[32:47], v[128:131], v[100:103], v[32:47]
    buffer_load_dwordx4 v150, s[16:19], s54 offen lds
    buffer_load_dwordx4 v151, s[16:19], s54 offen offset:1024 lds
    s_add_u32 s54, s54, 16384
    v_mfma_f32_32x32x16_bf16 v[48:63], v[132:135], v[100:103], v[48:63]
    s_waitcnt vmcnt(19) lgkmcnt(0)
    v_mfma_f32_32x32x16_bf16 v[0:15], v[120:123], v[104:107], v[0:15]
    ds_read_b64_tr_b16 v[128:129], v146 offset:12288
    ds_read_b64_tr_b16 v[130:131], v146 offset:13312
    ds_read_b64_tr_b16 v[132:133], v147 offset:12288
    ds_read_b64_tr_b16 v[134:135], v147 offset:13312
    v_mfma_f32_32x32x16_bf16 v[16:31], v[124:127], v[104:107], v[16:31]
    s_add_u32 m0, s49, 10240
    v_mfma_f32_32x32x16_bf16 v[32:47], v[120:123], v[108:111], v[32:47]
    buffer_load_dwordx4 v150, s[16:19], s54 offen lds
    buffer_load_dwordx4 v151, s[16:19], s54 offen offset:1024 lds
    s_add_u32 s54, s54, 16384
    v_mfma_f32_32x32x16_bf16 v[48:63], v[124:127], v[108:111], v[48:63]
    s_waitcnt vmcnt(20) lgkmcnt(0)
    v_mfma_f32_32x32x16_bf16 v[0:15], v[128:131], v[112:115], v[0:15]
    v_mfma_f32_32x32x16_bf16 v[16:31], v[132:135], v[112:115], v[16:31]
    s_add_u32 m0, s49, 12288
    v_mfma_f32_32x32x16_bf16 v[32:47], v[128:131], v[116:119], v[32:47]
    buffer_load_dwordx4 v150, s[16:19], s54 offen lds
    buffer_load_dwordx4 v151, s[16:19], s54 offen offset:1024 lds
    s_add_u32 s54, s54, 16384
    v_mfma_f32_32x32x16_bf16 v[48:63], v[132:135], v[116:119], v[48:63]
    s_setprio 3
    v_sub_f32 v182, 1.0, v164
    v_sub_f32 v184, 1.0, v165
    v_mov_b32 v164, v165
    s_waitcnt vmcnt(0) lgkmcnt(0)
    s_mov_b64 exec, 1
    ds_add_u32 v177, v167 offset:20
    s_mov_b64 exec, -1
    ds_read_b64_tr_b16 v[192:193], v146 offset:0
    ds_read_b64_tr_b16 v[194:195], v146 offset:1024
    ds_read_b64_tr_b16 v[196:197], v147 offset:0
    ds_read_b64_tr_b16 v[198:199], v147 offset:1024
    ds_read_b64_tr_b16 v[200:201], v146 offset:2048
    ds_read_b64_tr_b16 v[202:203], v146 offset:3072
    ds_read_b64_tr_b16 v[204:205], v147 offset:2048
    ds_read_b64_tr_b16 v[206:207], v147 offset:3072
    ds_read_b64_tr_b16 v[208:209], v146 offset:4096
    ds_read_b64_tr_b16 v[210:211], v146 offset:5120
    ds_read_b64_tr_b16 v[212:213], v147 offset:4096
    ds_read_b64_tr_b16 v[214:215], v147 offset:5120
    ds_read_b64_tr_b16 v[216:217], v146 offset:6144
    ds_read_b64_tr_b16 v[218:219], v146 offset:7168
    ds_read_b64_tr_b16 v[220:221], v147 offset:6144
    ds_read_b64_tr_b16 v[222:223], v147 offset:7168
    ds_read_b64_tr_b16 v[224:225], v146 offset:8192
    ds_read_b64_tr_b16 v[226:227], v146 offset:9216
    ds_read_b64_tr_b16 v[228:229], v147 offset:8192
    ds_read_b64_tr_b16 v[230:231], v147 offset:9216
    ds_read_b64_tr_b16 v[232:233], v146 offset:10240
    ds_read_b64_tr_b16 v[234:235], v146 offset:11264
    ds_read_b64_tr_b16 v[236:237], v147 offset:10240
    ds_read_b64_tr_b16 v[238:239], v147 offset:11264
    ds_read_b64_tr_b16 v[240:241], v146 offset:12288
    ds_read_b64_tr_b16 v[242:243], v146 offset:13312
    ds_read_b64_tr_b16 v[244:245], v147 offset:12288
    ds_read_b64_tr_b16 v[246:247], v147 offset:13312
    ds_read_b64_tr_b16 v[248:249], v146 offset:14336
    ds_read_b64_tr_b16 v[250:251], v146 offset:15360
    ds_read_b64_tr_b16 v[136:137], v147 offset:14336
    ds_read_b64_tr_b16 v[138:139], v147 offset:15360
    v_pk_mul_f32 v[0:1], v[0:1], v[182:183] op_sel_hi:[1,0]
    v_pk_mul_f32 v[2:3], v[2:3], v[182:183] op_sel_hi:[1,0]
    v_pk_mul_f32 v[4:5], v[4:5], v[182:183] op_sel_hi:[1,0]
    v_pk_mul_f32 v[6:7], v[6:7], v[182:183] op_sel_hi:[1,0]
    v_pk_mul_f32 v[8:9], v[8:9], v[182:183] op_sel_hi:[1,0]
    v_pk_mul_f32 v[10:11], v[10:11], v[182:183] op_sel_hi:[1,0]
    v_pk_mul_f32 v[12:13], v[12:13], v[182:183] op_sel_hi:[1,0]
    v_pk_mul_f32 v[14:15], v[14:15], v[182:183] op_sel_hi:[1,0]
    v_pk_mul_f32 v[16:17], v[16:17], v[182:183] op_sel_hi:[1,0]
    v_pk_mul_f32 v[18:19], v[18:19], v[182:183] op_sel_hi:[1,0]
    v_pk_mul_f32 v[20:21], v[20:21], v[182:183] op_sel_hi:[1,0]
    v_pk_mul_f32 v[22:23], v[22:23], v[182:183] op_sel_hi:[1,0]
    v_pk_mul_f32 v[24:25], v[24:25], v[182:183] op_sel_hi:[1,0]
    v_pk_mul_f32 v[26:27], v[26:27], v[182:183] op_sel_hi:[1,0]
    v_pk_mul_f32 v[28:29], v[28:29], v[182:183] op_sel_hi:[1,0]
    v_pk_mul_f32 v[30:31], v[30:31], v[182:183] op_sel_hi:[1,0]
    v_pk_mul_f32 v[32:33], v[32:33], v[184:185] op_sel_hi:[1,0]
    v_pk_mul_f32 v[34:35], v[34:35], v[184:185] op_sel_hi:[1,0]
    v_pk_mul_f32 v[36:37], v[36:37], v[184:185] op_sel_hi:[1,0]
    v_pk_mul_f32 v[38:39], v[38:39], v[184:185] op_sel_hi:[1,0]
    v_pk_mul_f32 v[40:41], v[40:41], v[184:185] op_sel_hi:[1,0]
    v_pk_mul_f32 v[42:43], v[42:43], v[184:185] op_sel_hi:[1,0]
    v_pk_mul_f32 v[44:45], v[44:45], v[184:185] op_sel_hi:[1,0]
    v_pk_mul_f32 v[46:47], v[46:47], v[184:185] op_sel_hi:[1,0]
    v_pk_mul_f32 v[48:49], v[48:49], v[184:185] op_sel_hi:[1,0]
    v_pk_mul_f32 v[50:51], v[50:51], v[184:185] op_sel_hi:[1,0]
    v_pk_mul_f32 v[52:53], v[52:53], v[184:185] op_sel_hi:[1,0]
    v_pk_mul_f32 v[54:55], v[54:55], v[184:185] op_sel_hi:[1,0]
    v_pk_mul_f32 v[56:57], v[56:57], v[184:185] op_sel_hi:[1,0]
    v_pk_mul_f32 v[58:59], v[58:59], v[184:185] op_sel_hi:[1,0]
    v_pk_mul_f32 v[60:61], v[60:61], v[184:185] op_sel_hi:[1,0]
    v_pk_mul_f32 v[62:63], v[62:63], v[184:185] op_sel_hi:[1,0]
    s_mov_b32 s63, 0
    s_branch L_o0_c
L_o0:
    buffer_load_dwordx4 v[64:67], v166, s[44:47], s10 offen offset:0 sc1
    buffer_load_dwordx4 v[68:71], v166, s[44:47], s65 offen offset:0 sc1
    buffer_load_dwordx4 v[72:75], v166, s[44:47], s10 offen offset:1024 sc1
    buffer_load_dwordx4 v[76:79], v166, s[44:47], s65 offen offset:1024 sc1
    buffer_load_dwordx4 v[80:83], v166, s[44:47], s10 offen offset:2048 sc1
    buffer_load_dwordx4 v[84:87], v166, s[44:47], s65 offen offset:2048 sc1
    buffer_load_dwordx4 v[88:91], v166, s[44:47], s10 offen offset:3072 sc1
    buffer_load_dwordx4 v[92:95], v166, s[44:47], s65 offen offset:3072 sc1
    s_add_u32 s63, s63, 1
    s_cmp_gt_u32 s63, 1000000
    s_cbranch_scc1 L_o0_x
L_o0_c:
    s_waitcnt vmcnt(7)
    v_max_u32 v178, v64, v66
    s_waitcnt vmcnt(6)
    v_max3_u32 v178, v178, v68, v70
    s_waitcnt vmcnt(5)
    v_max3_u32 v178, v178, v72, v74
    s_waitcnt vmcnt(4)
    v_max3_u32 v178, v178, v76, v78
    s_waitcnt vmcnt(3)
    v_max3_u32 v178, v178, v80, v82
    s_waitcnt vmcnt(2)
    v_max3_u32 v178, v178, v84, v86
    s_waitcnt vmcnt(1)
    v_max3_u32 v178, v178, v88, v90
    s_waitcnt vmcnt(0)
    v_max3_u32 v178, v178, v92, v94
    v_cmp_eq_u32 vcc, -1, v178
    s_cbranch_vccz L_o0_x
    s_sleep 4
    s_branch L_o0
L_o0_x:
    s_waitcnt vmcnt(0)
    s_waitcnt lgkmcnt(0)
    s_setprio 0
    v_mfma_f32_32x32x16_bf16 v[0:15], v[192:195], v[64:67], v[0:15]
    v_mfma_f32_32x32x16_bf16 v[16:31], v[196:199], v[64:67], v[16:31]
    v_mfma_f32_32x32x16_bf16 v[0:15], v[224:227], v[68:71], v[0:15]
    v_mfma_f32_32x32x16_bf16 v[16:31], v[228:231], v[68:71], v[16:31]
    v_mfma_f32_32x32x16_bf16 v[0:15], v[200:203], v[72:75], v[0:15]
    v_mfma_f32_32x32x16_bf16 v[16:31], v[204:207], v[72:75], v[16:31]
    v_mfma_f32_32x32x16_bf16 v[0:15], v[232:235], v[76:79], v[0:15]
    v_mfma_f32_32x32x16_bf16 v[16:31], v[236:239], v[76:79], v[16:31]
    v_mfma_f32_32x32x16_bf16 v[0:15], v[208:211], v[80:83], v[0:15]
    v_mfma_f32_32x32x16_bf16 v[16:31], v[212:215], v[80:83], v[16:31]
    v_mfma_f32_32x32x16_bf16 v[0:15], v[240:243], v[84:87], v[0:15]
    v_mfma_f32_32x32x16_bf16 v[16:31], v[244:247], v[84:87], v[16:31]
    v_mfma_f32_32x32x16_bf16 v[0:15], v[216:219], v[88:91], v[0:15]
    v_mfma_f32_32x32x16_bf16 v[16:31], v[220:223], v[88:91], v[16:31]
    v_mfma_f32_32x32x16_bf16 v[0:15], v[248:251], v[92:95], v[0:15]
    v_mfma_f32_32x32x16_bf16 v[16:31], v[136:139], v[92:95], v[16:31]
    s_setprio 3
    s_add_u32 s4, s8, 4096
    s_add_u32 s8, s10, 4096
    s_add_u32 s9, s65, 4096
    v_add_u32 v176, s32, v176
    v_add_u32 v181, s32, v181
    s_mul_i32 s5, s50, 10240
    s_cmp_lt_u32 s50, 2
    s_cselect_b32 s6, 151552, 0
    s_add_u32 s5, s5, s6
    s_sub_u32 s5, s49, s5
    s_add_u32 s5, s5, 28672
    ds_write_b128 v186, v[0:3] offset:0
    ds_write_b128 v187, v[4:7] offset:0
    ds_write_b128 v188, v[8:11] offset:0
    ds_write_b128 v189, v[12:15] offset:0
    ds_write_b128 v186, v[16:19] offset:128
    ds_write_b128 v187, v[20:23] offset:128
    ds_write_b128 v188, v[24:27] offset:128
    ds_write_b128 v189, v[28:31] offset:128
    s_mov_b64 exec, 1
    ds_add_u32 v177, v167 offset:28
    s_mov_b64 exec, -1
    s_mov_b32 s63, 0
L_w1:
    ds_read_b32 v178, v177 offset:20
    s_add_u32 s63, s63, 1
    s_cmp_gt_u32 s63, 1000000
    s_cbranch_scc1 L_w1_x
    s_waitcnt lgkmcnt(0)
    v_cmp_ne_u32 vcc, 4, v178
    s_cbranch_vccz L_w1_x
    s_sleep 2
    s_branch L_w1
L_w1_x:
    ds_read_b64_tr_b16 v[120:121], v253 offset:0
    ds_read_b64_tr_b16 v[122:123], v253 offset:1024
    ds_read_b64_tr_b16 v[124:125], v253 offset:32
    ds_read_b64_tr_b16 v[126:127], v253 offset:1056
    ds_read_b64_tr_b16 v[128:129], v253 offset:16384
    ds_read_b64_tr_b16 v[130:131], v253 offset:17408
    ds_read_b64_tr_b16 v[132:133], v253 offset:16416
    ds_read_b64_tr_b16 v[134:135], v253 offset:17440
    ds_read_b64_tr_b16 v[148:149], v253 offset:32768
    ds_read_b64_tr_b16 v[150:151], v253 offset:33792
    ds_read_b64_tr_b16 v[152:153], v253 offset:32800
    ds_read_b64_tr_b16 v[154:155], v253 offset:33824
    ds_read_b64_tr_b16 v[156:157], v253 offset:49152
    ds_read_b64_tr_b16 v[158:159], v253 offset:50176
    ds_read_b64_tr_b16 v[160:161], v253 offset:49184
    ds_read_b64_tr_b16 v[162:163], v253 offset:50208
    s_mov_b64 exec, 1
    ds_add_u32 v177, v167 offset:24
    s_mov_b64 exec, -1
    s_cmp_lt_u32 s50, 2
    s_cbranch_scc0 L_nf
    s_mov_b32 s58, s101
    s_call_b64 s[14:15], L_fin
L_nf:
    s_mov_b32 s63, 0
L_rw:
    ds_read_b32 v178, v177 offset:28
    s_add_u32 s63, s63, 1
    s_cmp_gt_u32 s63, 1000000
    s_cbranch_scc1 L_rw_x
    s_waitcnt lgkmcnt(0)
    v_cmp_ne_u32 vcc, 4, v178
    s_cbranch_vccz L_rw_x
    s_sleep 1
    s_branch L_rw
L_rw_x:
    ds_read_b128 v[0:3], v190 offset:0
    ds_read_b128 v[4:7], v191 offset:0
    ds_read_b128 v[8:11], v190 offset:10240
    ds_read_b128 v[12:15], v191 offset:10240
    ds_read_b128 v[16:19], v168 offset:0
    ds_read_b128 v[20:23], v169 offset:0
    ds_read_b128 v[24:27], v168 offset:10240
    ds_read_b128 v[28:31], v169 offset:10240
    v_add_u32 v186, s5, v186
    v_add_u32 v187, s5, v187
    v_add_u32 v188, s5, v188
    v_add_u32 v189, s5, v189
    s_waitcnt lgkmcnt(4)
    v_pk_add_f32 v[0:1], v[0:1], v[8:9]
    v_pk_add_f32 v[2:3], v[2:3], v[10:11]
    v_pk_add_f32 v[4:5], v[4:5], v[12:13]
    v_pk_add_f32 v[6:7], v[6:7], v[14:15]
    s_waitcnt lgkmcnt(0)
    v_pk_add_f32 v[16:17], v[16:17], v[24:25]
    v_pk_add_f32 v[18:19], v[18:19], v[26:27]
    v_pk_add_f32 v[20:21], v[20:21], v[28:29]
    v_pk_add_f32 v[22:23], v[22:23], v[30:31]
    v_pk_add_f32 v[0:1], v[0:1], v[16:17]
    v_pk_add_f32 v[2:3], v[2:3], v[18:19]
    v_pk_add_f32 v[4:5], v[4:5], v[20:21]
    v_pk_add_f32 v[6:7], v[6:7], v[22:23]
    v_cvt_pk_bf16_f32 v172, v0, v1
    v_cvt_pk_bf16_f32 v173, v2, v3
    v_cvt_pk_bf16_f32 v174, v4, v5
    v_cvt_pk_bf16_f32 v175, v6, v7
    buffer_store_dwordx4 v[172:175], v179, s[40:43], s33 offen sc1
    s_mov_b32 s63, 0
L_o1:
    buffer_load_dwordx4 v[96:99], v166, s[44:47], s8 offen offset:0 sc1
    buffer_load_dwordx4 v[100:103], v166, s[44:47], s9 offen offset:0 sc1
    buffer_load_dwordx4 v[104:107], v166, s[44:47], s8 offen offset:1024 sc1
    buffer_load_dwordx4 v[108:111], v166, s[44:47], s9 offen offset:1024 sc1
    s_add_u32 s63, s63, 1
    s_cmp_gt_u32 s63, 1000000
    s_cbranch_scc1 L_o1_x
L_o1_c:
    s_waitcnt vmcnt(3)
    v_max_u32 v178, v96, v98
    s_waitcnt vmcnt(2)
    v_max3_u32 v178, v178, v100, v102
    s_waitcnt vmcnt(1)
    v_max3_u32 v178, v178, v104, v106
    s_waitcnt vmcnt(0)
    v_max3_u32 v178, v178, v108, v110
    v_cmp_eq_u32 vcc, -1, v178
    s_cbranch_vccz L_o1_x
    s_sleep 4
    s_branch L_o1
L_o1_x:
    s_waitcnt vmcnt(0)
    s_waitcnt lgkmcnt(0)
    s_setprio 0
    v_mfma_f32_32x32x16_bf16 v[32:47], v[192:195], v[96:99], v[32:47]
    v_mfma_f32_32x32x16_bf16 v[48:63], v[196:199], v[96:99], v[48:63]
    v_mfma_f32_32x32x16_bf16 v[32:47], v[224:227], v[100:103], v[32:47]
    v_mfma_f32_32x32x16_bf16 v[48:63], v[228:231], v[100:103], v[48:63]
    v_mfma_f32_32x32x16_bf16 v[32:47], v[200:203], v[104:107], v[32:47]
    v_mfma_f32_32x32x16_bf16 v[48:63], v[204:207], v[104:107], v[48:63]
    v_mfma_f32_32x32x16_bf16 v[32:47], v[232:235], v[108:111], v[32:47]
    v_mfma_f32_32x32x16_bf16 v[48:63], v[236:239], v[108:111], v[48:63]
    s_setprio 3
    s_cmp_eq_u32 s50, 2
    s_cbranch_scc0 L_nf1
    s_mov_b32 s58, s101
    s_call_b64 s[14:15], L_fin
L_nf1:
    s_mov_b32 s63, 0
L_o1b:
    buffer_load_dwordx4 v[112:115], v166, s[44:47], s8 offen offset:2048 sc1
    buffer_load_dwordx4 v[116:119], v166, s[44:47], s9 offen offset:2048 sc1
    s_add_u32 s63, s63, 1
    s_cmp_gt_u32 s63, 1000000
    s_cbranch_scc1 L_o1b_x
L_o1b_c:
    s_waitcnt vmcnt(1)
    v_max_u32 v178, v112, v114
    s_waitcnt vmcnt(0)
    v_max3_u32 v178, v178, v116, v118
    v_cmp_eq_u32 vcc, -1, v178
    s_cbranch_vccz L_o1b_x
    s_sleep 4
    s_branch L_o1b
L_o1b_x:
    s_waitcnt vmcnt(0)
    s_waitcnt lgkmcnt(0)
    s_setprio 0
    v_mfma_f32_32x32x16_bf16 v[32:47], v[208:211], v[112:115], v[32:47]
    v_mfma_f32_32x32x16_bf16 v[48:63], v[212:215], v[112:115], v[48:63]
    v_mfma_f32_32x32x16_bf16 v[32:47], v[240:243], v[116:119], v[32:47]
    v_mfma_f32_32x32x16_bf16 v[48:63], v[244:247], v[116:119], v[48:63]
    s_setprio 3
    s_add_u32 s65, s11, 32768
    buffer_load_dwordx4 v[108:111], v252, s[44:47], s11 offen sc1
    buffer_load_dwordx4 v[104:107], v254, s[44:47], s11 offen sc1
    buffer_load_dwordx4 v[100:103], v252, s[44:47], s65 offen sc1
    buffer_load_dwordx4 v[140:143], v254, s[44:47], s65 offen sc1
    s_mov_b32 s63, 0
L_w2:
    ds_read_b32 v178, v177 offset:24
    s_add_u32 s63, s63, 1
    s_cmp_gt_u32 s63, 1000000
    s_cbranch_scc1 L_w2_x
    s_waitcnt lgkmcnt(0)
    v_cmp_ne_u32 vcc, 4, v178
    s_cbranch_vccz L_w2_x
    s_sleep 2
    s_branch L_w2
L_w2_x:
    s_nop 2
    ds_write_b128 v186, v[32:35] offset:0
    ds_write_b128 v187, v[36:39] offset:0
    ds_write_b128 v188, v[40:43] offset:0
    ds_write_b128 v189, v[44:47] offset:0
    ds_write_b128 v186, v[48:51] offset:128
    ds_write_b128 v187, v[52:55] offset:128
    ds_write_b128 v188, v[56:59] offset:128
    ds_write_b128 v189, v[60:63] offset:128
    s_mov_b64 exec, 1
    ds_add_u32 v177, v167 offset:32
    s_mov_b64 exec, -1
    s_mov_b32 s63, 0
L_rw1:
    ds_read_b32 v178, v177 offset:32
    s_add_u32 s63, s63, 1
    s_cmp_gt_u32 s63, 1000000
    s_cbranch_scc1 L_rw1_x
    s_waitcnt lgkmcnt(0)
    v_cmp_ne_u32 vcc, 4, v178
    s_cbranch_vccz L_rw1_x
    s_sleep 1
    s_branch L_rw1
L_rw1_x:
    ds_read_b128 v[64:67], v183 offset:0
    ds_read_b128 v[68:71], v185 offset:0
    ds_read_b128 v[72:75], v183 offset:16384
    ds_read_b128 v[76:79], v185 offset:16384
    ds_read_b128 v[80:83], v183 offset:32768
    ds_read_b128 v[84:87], v185 offset:32768
    ds_read_b128 v[88:91], v183 offset:49152
    ds_read_b128 v[92:95], v185 offset:49152
    s_waitcnt lgkmcnt(4)
    v_pk_add_f32 v[64:65], v[64:65], v[72:73]
    v_pk_add_f32 v[66:67], v[66:67], v[74:75]
    v_pk_add_f32 v[68:69], v[68:69], v[76:77]
    v_pk_add_f32 v[70:71], v[70:71], v[78:79]
    s_waitcnt lgkmcnt(0)
    v_pk_add_f32 v[80:81], v[80:81], v[88:89]
    v_pk_add_f32 v[82:83], v[82:83], v[90:91]
    v_pk_add_f32 v[84:85], v[84:85], v[92:93]
    v_pk_add_f32 v[86:87], v[86:87], v[94:95]
    v_pk_add_f32 v[0:1], v[64:65], v[80:81]
    v_pk_add_f32 v[2:3], v[66:67], v[82:83]
    v_pk_add_f32 v[4:5], v[68:69], v[84:85]
    v_pk_add_f32 v[6:7], v[70:71], v[86:87]
    v_add_u32 v171, 51200, v166
    s_cmp_eq_u32 s50, 3
    s_barrier
    s_cbranch_scc0 L_nf2
    ds_read2st64_b32 v[96:97], v170 offset0:32 offset1:33
    ds_read2st64_b32 v[98:99], v170 offset0:34 offset1:35
    ds_read_b128 v[64:67], v171 offset:0
    ds_read_b128 v[68:71], v171 offset:4096
    ds_read_b128 v[72:75], v171 offset:1024
    ds_read_b128 v[76:79], v171 offset:5120
    ds_read_b128 v[80:83], v171 offset:2048
    ds_read_b128 v[84:87], v171 offset:6144
    ds_read_b128 v[88:91], v171 offset:3072
    ds_read_b128 v[92:95], v171 offset:7168
    s_cmp_eq_u32 s101, 1
    s_waitcnt lgkmcnt(8)
    v_pk_add_f32 v[96:97], v[96:97], v[98:99]
    s_waitcnt lgkmcnt(4)
    v_add_f32 v96, v96, v97
    v_pk_add_f32 v[64:65], v[64:65], v[72:73]
    v_pk_add_f32 v[66:67], v[66:67], v[74:75]
    v_pk_add_f32 v[68:69], v[68:69], v[76:77]
    v_pk_add_f32 v[70:71], v[70:71], v[78:79]
    v_rcp_f32 v96, v96
    s_waitcnt lgkmcnt(0)
    v_pk_add_f32 v[80:81], v[80:81], v[88:89]
    v_pk_add_f32 v[82:83], v[82:83], v[90:91]
    v_pk_add_f32 v[84:85], v[84:85], v[92:93]
    v_pk_add_f32 v[86:87], v[86:87], v[94:95]
    v_mul_f32 v96, v96, v164
    v_pk_add_f32 v[64:65], v[64:65], v[80:81]
    v_pk_add_f32 v[66:67], v[66:67], v[82:83]
    v_pk_add_f32 v[68:69], v[68:69], v[84:85]
    v_pk_add_f32 v[70:71], v[70:71], v[86:87]
    v_pk_mul_f32 v[64:65], v[64:65], v[96:97] op_sel_hi:[1,0]
    v_pk_mul_f32 v[66:67], v[66:67], v[96:97] op_sel_hi:[1,0]
    v_pk_mul_f32 v[68:69], v[68:69], v[96:97] op_sel_hi:[1,0]
    v_pk_mul_f32 v[70:71], v[70:71], v[96:97] op_sel_hi:[1,0]
    v_cvt_pk_bf16_f32 v64, v64, v65
    v_cvt_pk_bf16_f32 v65, v66, v67
    v_cvt_pk_bf16_f32 v66, v68, v69
    v_cvt_pk_bf16_f32 v67, v70, v71
    v_min_u32 v64, -2, v64
    v_min_u32 v65, -2, v65
    v_min_u32 v66, -2, v66
    v_min_u32 v67, -2, v67
    s_cbranch_scc1 L_hs2a
    buffer_store_dwordx4 v[64:67], v166, s[44:47], s4 offen sc1
    s_branch L_hs2b
L_hs2a:
    buffer_store_dwordx4 v[64:67], v166, s[44:47], s4 offen
L_hs2b:
L_nf2:
    s_mov_b32 s63, 0
L_o2:
    buffer_load_dwordx4 v[108:111], v252, s[44:47], s11 offen sc1
    buffer_load_dwordx4 v[104:107], v254, s[44:47], s11 offen sc1
    buffer_load_dwordx4 v[100:103], v252, s[44:47], s65 offen sc1
    buffer_load_dwordx4 v[140:143], v254, s[44:47], s65 offen sc1
    s_add_u32 s63, s63, 1
    s_cmp_gt_u32 s63, 1000000
    s_cbranch_scc1 L_o2_x
L_o2_c:
    s_waitcnt vmcnt(3)
    v_max_u32 v178, v108, v110
    s_waitcnt vmcnt(2)
    v_max3_u32 v178, v178, v104, v106
    s_waitcnt vmcnt(1)
    v_max3_u32 v178, v178, v100, v102
    s_waitcnt vmcnt(0)
    v_max3_u32 v178, v178, v140, v142
    v_cmp_eq_u32 vcc, -1, v178
    s_cbranch_vccz L_o2_x
    s_branch L_o2
L_o2_x:
    s_waitcnt vmcnt(0)
    v_mfma_f32_16x16x32_bf16 v[0:3], v[120:123], v[108:111], v[0:3]
    v_mfma_f32_16x16x32_bf16 v[4:7], v[124:127], v[108:111], v[4:7]
    v_mfma_f32_16x16x32_bf16 v[0:3], v[128:131], v[104:107], v[0:3]
    v_mfma_f32_16x16x32_bf16 v[4:7], v[132:135], v[104:107], v[4:7]
    v_mfma_f32_16x16x32_bf16 v[0:3], v[148:151], v[100:103], v[0:3]
    v_mfma_f32_16x16x32_bf16 v[4:7], v[152:155], v[100:103], v[4:7]
    v_mfma_f32_16x16x32_bf16 v[0:3], v[156:159], v[140:143], v[0:3]
    v_mfma_f32_16x16x32_bf16 v[4:7], v[160:163], v[140:143], v[4:7]
    s_nop 6
    v_cvt_pk_bf16_f32 v8, v0, v1
    v_cvt_pk_bf16_f32 v9, v2, v3
    v_cvt_pk_bf16_f32 v10, v4, v5
    v_cvt_pk_bf16_f32 v11, v6, v7
    s_nop 1
    v_permlane16_swap_b32 v8, v10
    v_permlane16_swap_b32 v9, v11
    buffer_store_dwordx4 v[8:11], v180, s[40:43], s34 offen
    s_branch L_gend
L_gsetupx:
    s_mov_b32 s55, s38
    s_call_b64 s[38:39], L_gsetup
    s_call_b64 s[38:39], L_gsetup2
    s_mov_b32 s38, s55
    s_mov_b32 s39, 0x00020000
    s_setpc_b64 s[58:59]
L_gsetup:
    s_sub_u32 s101, s50, 4
    s_lshr_b32 s48, s52, 1
    s_mul_i32 s48, s48, 7
    s_and_b32 s63, s52, 1
    s_lshl_b32 s62, s63, 2
    s_add_u32 s62, s62, s101
    s_cmp_eq_u32 s101, 3
    s_cselect_b32 s62, 3, s62
    s_cselect_b32 s63, s63, 0
    s_add_u32 s48, s48, s62
    s_lshl_b32 s48, s48, 1
    s_add_u32 s48, s48, s63
    s_lshl_b32 s100, s48, 6
    s_mul_i32 s54, s3, 458752
    s_add_u32 s54, s54, s100
    s_lshl_b32 s49, s101, 14
    s_add_u32 s49, s49, 65536
    v_lshrrev_b32 v14, 3, v255
    v_and_b32 v15, 7, v255
    v_bfe_u32 v3, v255, 4, 1
    v_lshlrev_b32 v3, 2, v3
    v_xor_b32 v2, v3, v15
    v_lshlrev_b32 v2, 4, v2
    v_lshl_or_b32 v150, v14, 10, v2
    v_add_u32 v151, 7168, v150
    v_mul_u32_u24 v148, 3584, v14
    v_add_u32 v148, v148, v2
    v_add_u32 v149, 27648, v148
    v_lshlrev_b32 v180, 5, v15
    v_lshlrev_b32 v2, 1, v15
    v_xor_b32 v2, v14, v2
    v_lshlrev_b32 v2, 4, v2
    v_lshl_or_b32 v190, v14, 8, v2
    s_lshl_b32 s62, s101, 11
    s_add_u32 s62, s62, 131072
    v_add_u32 v190, s62, v190
    v_xor_b32 v191, 16, v190
    v_lshlrev_b32 v2, 4, v15
    v_lshl_or_b32 v179, v14, 10, v2
    v_and_b32 v1, 31, v255
    v_lshrrev_b32 v14, 5, v255
    v_xor_b32 v2, v14, v15
    v_lshlrev_b32 v2, 4, v2
    v_lshl_or_b32 v186, v1, 8, v2
    s_mul_i32 s62, s52, 7
    s_sub_u32 s62, s48, s62
    s_lshl_b32 s62, s62, 6
    s_add_u32 s62, s62, 162880
    v_lshlrev_b32 v13, 1, v1
    v_add_u32 v12, s62, v13
    v_add_u32 v13, 163328, v13
    v_lshlrev_b32 v192, 2, v1
    v_add_u32 v192, 159744, v192
    v_and_b32 v3, 15, v255
    v_xor_b32 v3, v14, v3
    v_lshlrev_b32 v3, 4, v3
    v_lshl_or_b32 v136, v1, 8, v3
    v_xor_b32 v137, 32, v136
    v_xor_b32 v138, 64, v136
    v_xor_b32 v139, 96, v136
    v_xor_b32 v140, 128, v136
    v_xor_b32 v141, 160, v136
    v_xor_b32 v142, 192, v136
    v_xor_b32 v143, 224, v136
    v_lshrrev_b32 v1, 5, v255
    v_bfe_u32 v2, v255, 2, 2
    v_mad_u32_u24 v1, v1, 8, v2
    v_lshlrev_b32 v1, 7, v1
    v_bfe_u32 v2, v255, 3, 1
    v_lshl_or_b32 v1, v2, 6, v1
    v_bfe_u32 v2, v255, 4, 1
    v_lshl_or_b32 v1, v2, 5, v1
    v_and_b32 v2, 3, v255
    v_lshl_or_b32 v144, v2, 3, v1
    v_add_u32 v144, s49, v144
    v_xor_b32 v145, 64, v144
    s_setpc_b64 s[38:39]
L_gsetup2:
    v_lshrrev_b32 v1, 5, v255
    v_bfe_u32 v2, v255, 2, 2
    v_mad_u32_u24 v1, v1, 4, v2
    v_lshlrev_b32 v1, 7, v1
    v_bfe_u32 v2, v255, 3, 1
    v_lshl_or_b32 v1, v2, 6, v1
    v_bfe_u32 v2, v255, 4, 1
    v_lshl_or_b32 v1, v2, 5, v1
    v_and_b32 v2, 3, v255
    v_lshl_or_b32 v146, v2, 3, v1
    v_add_u32 v146, s49, v146
    v_xor_b32 v147, 64, v146
    v_mov_b32 v153, 0
    v_mov_b32 v154, 0
    v_mov_b32 v155, 0
    v_mov_b32 v157, 0
    v_mov_b32 v158, 0
    v_mov_b32 v159, 0
    v_mov_b32 v161, 0
    v_mov_b32 v162, 0
    v_mov_b32 v163, 0
    v_mov_b32 v169, 0
    v_mov_b32 v170, 0
    v_mov_b32 v171, 0
    v_mov_b32 v173, 0
    v_mov_b32 v174, 0
    v_mov_b32 v175, 0
    v_cmp_gt_u32 vcc, 32, v255
    v_mov_b32 v1, 0x3f80
    v_lshlrev_b32 v166, 4, v255
    v_cndmask_b32 v160, 0, v1, vcc
    v_mov_b32 v167, 1
    v_mov_b32 v177, 160016
    v_mov_b64 v[200:201], -1
    v_mov_b64 v[202:203], -1
    s_and_b32 s62, s101, 1
    s_lshr_b32 s63, s101, 1
    v_and_b32 v1, 15, v255
    v_lshl_add_u32 v1, s62, 4, v1
    v_lshrrev_b32 v2, 4, v255
    v_xor_b32 v3, v2, v15
    v_lshlrev_b32 v3, 4, v3
    v_lshl_or_b32 v3, v1, 8, v3
    s_lshl_b32 s62, s63, 7
    s_add_u32 s62, s62, 73728
    v_add_u32 v183, s62, v3
    v_xor_b32 v185, 64, v183
    v_and_b32 v3, 1, v2
    v_lshl_add_u32 v252, v3, 5, v1
    v_lshlrev_b32 v252, 4, v252
    v_lshl_add_u32 v252, v14, 13, v252
    v_add_u32 v254, 0x4000, v252
    v_lshlrev_b32 v193, 10, v1
    v_lshl_or_b32 v193, v3, 5, v193
    v_lshl_or_b32 v193, v14, 4, v193
    s_lshl_b32 s62, s63, 6
    v_add_u32 v193, s62, v193
    v_bfe_u32 v1, v255, 2, 2
    v_lshl_or_b32 v1, v3, 2, v1
    v_lshlrev_b32 v1, 7, v1
    v_lshl_or_b32 v1, v14, 13, v1
    v_bfe_u32 v2, v255, 3, 1
    v_xor_b32 v2, s63, v2
    v_lshl_or_b32 v1, v2, 6, v1
    v_and_b32 v2, 3, v255
    v_lshl_or_b32 v1, v2, 3, v1
    v_add_u32 v253, 71680, v1
    v_lshlrev_b32 v196, 7, v255
    v_lshlrev_b32 v198, 2, v255
    v_add_u32 v198, 51200, v198
    s_lshl_b32 s62, s101, 11
    v_add_u32 v199, s62, v198
    s_mul_i32 s62, s101, 10240
    s_add_u32 s63, s62, 131072
    s_sub_u32 s62, s62, 20480
    s_cmp_lt_u32 s101, 2
    s_cselect_b32 s62, s63, s62
    v_lshlrev_b32 v181, 2, v255
    v_add_u32 v181, s62, v181
    v_add_u32 v186, s62, v186
    v_xor_b32 v187, 32, v186
    v_xor_b32 v188, 64, v186
    v_xor_b32 v189, 0x60, v186
    s_add_u32 s62, s62, 9468
    v_lshl_add_u32 v176, v2, 8, s62
    s_cmp_eq_u32 s101, 3
    s_cbranch_scc0 L_gsx
    v_bfe_u32 v2, v255, 2, 2
    v_lshl_or_b32 v2, v14, 3, v2
    v_lshlrev_b32 v2, 6, v2
    v_bfe_u32 v3, v255, 4, 1
    v_lshl_or_b32 v2, v3, 5, v2
    v_and_b32 v3, 3, v255
    v_lshl_or_b32 v2, v3, 3, v2
    v_add_u32 v144, s49, v2
    v_lshlrev_b32 v145, 4, v14
    v_add_u32 v145, 161792, v145
    v_lshrrev_b32 v1, 2, v255
    v_mul_u32_u24 v148, 3584, v1
    v_lshl_add_u32 v148, v3, 4, v148
L_gsx:
    s_setpc_b64 s[38:39]
L_fin:
    s_mov_b32 s63, 0
L_fwf:
    ds_read_b32 v64, v176
    s_add_u32 s63, s63, 1
    s_cmp_gt_u32 s63, 1000000
    s_cbranch_scc1 L_fwf_x
    s_waitcnt lgkmcnt(0)
    v_cmp_ne_u32 vcc, s53, v64
    s_cbranch_vccz L_fwf_x
    s_sleep 3
    s_branch L_fwf
L_fwf_x:
    ds_read2st64_b32 v[96:97], v181 offset0:32 offset1:33
    ds_read2st64_b32 v[98:99], v181 offset0:34 offset1:35
    ds_read2st64_b32 v[64:65], v181 offset0:0 offset1:4
    ds_read2st64_b32 v[66:67], v181 offset0:8 offset1:12
    ds_read2st64_b32 v[68:69], v181 offset0:16 offset1:20
    ds_read2st64_b32 v[70:71], v181 offset0:24 offset1:28
    ds_read2st64_b32 v[72:73], v181 offset0:1 offset1:5
    ds_read2st64_b32 v[74:75], v181 offset0:9 offset1:13
    ds_read2st64_b32 v[76:77], v181 offset0:17 offset1:21
    ds_read2st64_b32 v[78:79], v181 offset0:25 offset1:29
    ds_read2st64_b32 v[80:81], v181 offset0:2 offset1:6
    ds_read2st64_b32 v[82:83], v181 offset0:10 offset1:14
    ds_read2st64_b32 v[84:85], v181 offset0:18 offset1:22
    ds_read2st64_b32 v[86:87], v181 offset0:26 offset1:30
    ds_read2st64_b32 v[88:89], v181 offset0:3 offset1:7
    ds_read2st64_b32 v[90:91], v181 offset0:11 offset1:15
    ds_read2st64_b32 v[92:93], v181 offset0:19 offset1:23
    ds_read2st64_b32 v[94:95], v181 offset0:27 offset1:31
    s_cmp_eq_u32 s58, 1
    s_waitcnt lgkmcnt(8)
    v_pk_add_f32 v[96:97], v[96:97], v[98:99]
    v_pk_add_f32 v[64:65], v[64:65], v[72:73]
    v_pk_add_f32 v[66:67], v[66:67], v[74:75]
    v_pk_add_f32 v[68:69], v[68:69], v[76:77]
    v_pk_add_f32 v[70:71], v[70:71], v[78:79]
    v_add_f32 v96, v96, v97
    s_waitcnt lgkmcnt(0)
    v_pk_add_f32 v[80:81], v[80:81], v[88:89]
    v_pk_add_f32 v[82:83], v[82:83], v[90:91]
    v_pk_add_f32 v[84:85], v[84:85], v[92:93]
    v_pk_add_f32 v[86:87], v[86:87], v[94:95]
    v_rcp_f32 v96, v96
    v_pk_add_f32 v[64:65], v[64:65], v[80:81]
    v_pk_add_f32 v[66:67], v[66:67], v[82:83]
    v_pk_add_f32 v[68:69], v[68:69], v[84:85]
    v_pk_add_f32 v[70:71], v[70:71], v[86:87]
    v_mul_f32 v96, v96, v164
    v_pk_mul_f32 v[64:65], v[64:65], v[96:97] op_sel_hi:[1,0]
    v_pk_mul_f32 v[66:67], v[66:67], v[96:97] op_sel_hi:[1,0]
    v_pk_mul_f32 v[68:69], v[68:69], v[96:97] op_sel_hi:[1,0]
    v_pk_mul_f32 v[70:71], v[70:71], v[96:97] op_sel_hi:[1,0]
    v_cvt_pk_bf16_f32 v64, v64, v65
    v_cvt_pk_bf16_f32 v65, v66, v67
    v_cvt_pk_bf16_f32 v66, v68, v69
    v_cvt_pk_bf16_f32 v67, v70, v71
    v_min_u32 v64, -2, v64
    v_min_u32 v65, -2, v65
    v_min_u32 v66, -2, v66
    v_min_u32 v67, -2, v67
    s_cbranch_scc1 L_hs3a
    buffer_store_dwordx4 v[64:67], v166, s[44:47], s4 offen sc1
    s_branch L_hs3b
L_hs3a:
    buffer_store_dwordx4 v[64:67], v166, s[44:47], s4 offen
L_hs3b:
    s_nop 0
    s_setpc_b64 s[14:15]
L_gend:
L_end:
    s_endpgm
.section .rodata,"a"
.p2align 6
.amdhsa_kernel gated_mix__grouped_kv_mqa__dense_activation_squared_relu__prompt_kernel
  .amdhsa_next_free_vgpr 256
  .amdhsa_next_free_sgpr 102
  .amdhsa_accum_offset 256
  .amdhsa_group_segment_fixed_size 0
  .amdhsa_kernarg_size 112
  .amdhsa_user_sgpr_count 2
  .amdhsa_user_sgpr_kernarg_segment_ptr 1
  .amdhsa_system_sgpr_workgroup_id_x 1
.end_amdhsa_kernel
```
